```python
import torch

def _softmax(x, axis=-1):
    return torch.softmax(x, dim=axis)
def _gelu(x):
    return torch.nn.functional.gelu(x, approximate="tanh")
def _silu(x):
    return torch.nn.functional.silu(x)
def _sigmoid(x):
    return torch.sigmoid(x)
def _layernorm(x, axis=-1, eps=1e-5):
    m = x.mean(dim=axis, keepdim=True)
    v = x.var(dim=axis, keepdim=True, unbiased=False)
    return (x - m) / torch.sqrt(v + eps)
def _scatter_add(tgt, idx, src, axis=0):
    return tgt.clone().index_add_(axis, idx, src)
def _segment_sum(src, seg, n):
    out = torch.zeros((n,) + src.shape[1:], dtype=src.dtype)
    return out.index_add_(0, seg, src)
def _pad(x, pw):
    flat = tuple(v for pair in reversed(pw) for v in pair)
    return torch.nn.functional.pad(x, flat)

kernel_name = 'recurrent_scan__sliding_block_cached__mixer_token_mlp__decode'

def setup_inputs():

    _w = (lambda a: (lambda t: t.to(torch.bfloat16) if t.is_floating_point() else t)(torch.as_tensor(a)))
    def _A_setup():
        B, Sq, D = 1, 1, 576
        Hq, Hkv, Sk, Dh = 32, 16, 65536, 128
        assert Hq % Hkv == 0, (Hq, Hkv)
        return {
            "x": _w((lambda *s: torch.randn(*s, dtype=torch.bfloat16) * 0.05)(B, Sq, D)),
            "k_cache": _w((lambda *s: torch.randn(*s, dtype=torch.bfloat16) * 3.2)(B, Hkv, Sk, Dh)),
            "v_cache": _w((lambda *s: torch.randn(*s, dtype=torch.bfloat16) * 3.2)(B, Hkv, Sk, Dh)),
            "wq": _w((lambda *s: torch.randn(*s, dtype=torch.bfloat16) * 3.2)(D, Hq * Dh) * (D ** -0.5)),
            "wo": _w((lambda *s: torch.randn(*s, dtype=torch.bfloat16) * 3.2)(Hq * Dh, D) * ((Hq * Dh) ** -0.5)),
        }
    _A_in = _A_setup()

    def _B_setup():
        B, S, D, F = 1, 1, 576, 4608
        return {
            "x": _w((lambda *s: torch.randn(*s, dtype=torch.bfloat16) * 0.05)(B, S, D)),
            "w1": _w((lambda *s: torch.randn(*s, dtype=torch.bfloat16) * 3.2)(S, F) * (S ** -0.5)),
            "b1": _w((lambda *s: torch.randn(*s, dtype=torch.bfloat16) * 3.2)(F) * 0.02),
            "w2": _w((lambda *s: torch.randn(*s, dtype=torch.bfloat16) * 0.4)(F, S) * (F ** -0.5)),
            "b2": _w((lambda *s: torch.randn(*s, dtype=torch.bfloat16) * 0.4)(S) * 0.02),
        }
    _B_in = _B_setup()

    return {
        "A_x": _A_in["x"],
        "A_k_cache": _A_in["k_cache"],
        "A_v_cache": _A_in["v_cache"],
        "A_wq": _A_in["wq"],
        "A_wo": _A_in["wo"],
        "B_x": _B_in["x"],
        "B_w1": _B_in["w1"],
        "B_b1": _B_in["b1"],
        "B_w2": _B_in["w2"],
        "B_b2": _B_in["b2"],
    }

def reference(A_x, A_k_cache, A_v_cache, A_wq, A_wo, B_x, B_w1, B_b1, B_w2, B_b2):
    def _A_ref(x, k_cache, v_cache, wq, wo):
        B, Sq, D = x.shape
        Hq, Dh = 32, 128
        Hkv, Sk = k_cache.shape[1], k_cache.shape[2]
        W = min(4096, max(256, Sk // 4))
        rep = Hq // Hkv
        q = (lambda x, *d: x.permute(*d))((x @ wq).reshape(B, Sq, Hq, Dh), 0, 2, 1, 3)
        k = (lambda x, n, axis: torch.repeat_interleave(x, n, dim=axis))(k_cache[:, :, Sk - W:, :], rep, axis=1)
        v = (lambda x, n, axis: torch.repeat_interleave(x, n, dim=axis))(v_cache[:, :, Sk - W:, :], rep, axis=1)
        scores = torch.einsum("bhqd,bhkd->bhqk", q, k) * (Dh ** -0.5)
        p = _softmax(scores, axis=-1)
        o = torch.einsum("bhqk,bhkd->bhqd", p, v)
        return (lambda x, *d: x.permute(*d))(o, 0, 2, 1, 3).reshape(B, Sq, Hq * Dh) @ wo

    def _B_ref(x, w1, b1, w2, b2):
        B, S, D = x.shape
        h = _layernorm(x, axis=-1)
        u = torch.einsum("bsd,sf->bdf", h, w1) + b1
        u = _gelu(u)
        y = torch.einsum("bdf,fs->bds", u, w2) + b2
        return (lambda x, *d: x.permute(*d))(y, 0, 2, 1)

    x = A_x
    xn = _layernorm(x, axis=-1)
    s = _A_ref(xn, A_k_cache, A_v_cache, A_wq, A_wo)
    g = _silu(_B_ref(xn, B_w1, B_b1, B_w2, B_b2))
    return x + s * g
```

```asm
; @launch grid=(256,1,1) block=(512,1,1) lds=22528
.amdgcn_target "amdgcn-amd-amdhsa--gfx950"
.text
.globl recurrent_scan__sliding_block_cached__mixer_token_mlp__decode_kernel
.p2align 8
.type recurrent_scan__sliding_block_cached__mixer_token_mlp__decode_kernel,@function
recurrent_scan__sliding_block_cached__mixer_token_mlp__decode_kernel:
  s_cmp_ge_u32 s2, 256
  s_cbranch_scc1 L_end
  s_getpc_b64 s[92:93]
L_pc:
  s_load_dwordx16 s[16:31], s[0:1], 0
  s_load_dwordx8 s[32:39], s[0:1], 64
  s_load_dwordx2 s[40:41], s[0:1], 96
  s_and_b32 s42, s2, 7
  s_lshl_b32 s42, s42, 1
  s_bfe_u32 s53, s2, 0x10003
  s_or_b32 s42, s42, s53
  s_lshr_b32 s43, s2, 4
  s_lshr_b32 s44, s43, 2
  s_and_b32 s45, s43, 3
  s_lshl_b32 s46, s42, 24
  s_lshl_b32 s53, s43, 16
  s_add_u32 s46, s46, s53
  s_add_u32 s46, s46, 15732736
  s_mul_i32 s53, s43, 0x5556
  s_lshr_b32 s53, s53, 16
  s_mul_i32 s54, s53, 3
  s_sub_u32 s51, s43, s54
  s_lshl_b32 s50, s42, 2
  s_add_u32 s50, s50, s53
  s_sub_u32 s52, s43, 12
  s_lshl_b32 s52, s52, 4
  s_add_u32 s52, s52, s42
  v_and_b32 v1, 63, v0
  v_lshrrev_b32 v28, 6, v0
  v_lshrrev_b32 v24, 4, v1
  v_bfe_u32 v25, v1, 3, 1
  v_and_b32 v26, 7, v1
  v_and_b32 v27, 15, v1
  v_readfirstlane_b32 s47, v28
  v_lshlrev_b32 v7, 2, v1
  v_lshl_add_u32 v29, v24, 1, v25
  s_cmp_ge_u32 s47, 4
  s_cbranch_scc1 L_S
  s_cmp_ge_u32 s47, 1
  s_cbranch_scc1 L_M
  s_mul_i32 s53, s44, 144
  v_add_u32 v71, s53, v29
  s_lshl_b32 s53, s42, 9
  s_lshl_b32 s54, s45, 7
  s_add_u32 s53, s53, s54
  v_lshl_add_u32 v18, v26, 4, s53
  v_lshl_add_u32 v71, v71, 13, v18
  v_mov_b32 v8, 0
  v_lshlrev_b32 v9, 2, v1
  s_mov_b32 exec_hi, 0
  ds_write_b32 v9, v8 offset:1664
  s_mov_b64 exec, -1
  s_waitcnt lgkmcnt(0)
  s_load_dword s49, s[40:41], 0
  s_add_u32 s60, s40, 2097152
  s_addc_u32 s61, s41, 0
  v_add_u32 v70, 1024, v7
  v_min_u32 v70, 1148, v70
  global_load_dword v52, v7, s[16:17] offset:0
  global_load_dword v53, v7, s[16:17] offset:256
  global_load_dword v54, v7, s[16:17] offset:512
  global_load_dword v55, v7, s[16:17] offset:768
  global_load_dword v56, v70, s[16:17]
  global_load_dwordx4 v[72:75], v71, s[22:23] nt
  v_add_u32 v71, 0x10000, v71
  global_load_dwordx4 v[76:79], v71, s[22:23] nt
  v_add_u32 v71, 0x10000, v71
  global_load_dwordx4 v[80:83], v71, s[22:23] nt
  v_add_u32 v71, 0x10000, v71
  global_load_dwordx4 v[84:87], v71, s[22:23] nt
  v_add_u32 v71, 0x10000, v71
  global_load_dwordx4 v[88:91], v71, s[22:23] nt
  v_add_u32 v71, 0x10000, v71
  global_load_dwordx4 v[92:95], v71, s[22:23] nt
  v_add_u32 v71, 0x10000, v71
  global_load_dwordx4 v[96:99], v71, s[22:23] nt
  v_add_u32 v71, 0x10000, v71
  global_load_dwordx4 v[100:103], v71, s[22:23] nt
  v_add_u32 v71, 0x10000, v71
  global_load_dwordx4 v[104:107], v71, s[22:23] nt
  v_add_u32 v71, 0x10000, v71
  global_load_dwordx4 v[108:111], v71, s[22:23] nt
  v_add_u32 v71, 0x10000, v71
  global_load_dwordx4 v[112:115], v71, s[22:23] nt
  v_add_u32 v71, 0x10000, v71
  global_load_dwordx4 v[116:119], v71, s[22:23] nt
  v_add_u32 v71, 0x10000, v71
  global_load_dwordx4 v[120:123], v71, s[22:23] nt
  v_add_u32 v71, 0x10000, v71
  global_load_dwordx4 v[124:127], v71, s[22:23] nt
  v_add_u32 v71, 0x10000, v71
  global_load_dwordx4 v[128:131], v71, s[22:23] nt
  v_add_u32 v71, 0x10000, v71
  global_load_dwordx4 v[132:135], v71, s[22:23] nt
  v_add_u32 v71, 0x10000, v71
  global_load_dwordx4 v[136:139], v71, s[22:23] nt
  v_add_u32 v71, 0x10000, v71
  global_load_dwordx4 v[140:143], v71, s[22:23] nt
  s_barrier
  v_and_b32 v21, 1, v1
  v_lshlrev_b32 v21, 4, v21
  v_mul_u32_u24 v22, 0x202, v25
  v_add_u32 v22, 0x100, v22
  v_lshlrev_b32 v22, v21, v22
  v_sub_u32 v21, 16, v21
  v_mov_b32 v23, 0xc0c
  v_lshlrev_b32 v23, v21, v23
  v_or_b32 v22, v22, v23
  v_mov_b32 v23, 0x0c0c0c0c
  v_bfe_u32 v20, v1, 1, 2
  v_cmp_eq_u32 vcc, 0, v20
  s_nop 1
  v_cndmask_b32 v30, v23, v22, vcc
  v_cmp_eq_u32 vcc, 1, v20
  s_nop 1
  v_cndmask_b32 v31, v23, v22, vcc
  v_cmp_eq_u32 vcc, 2, v20
  s_nop 1
  v_cndmask_b32 v32, v23, v22, vcc
  v_cmp_eq_u32 vcc, 3, v20
  s_nop 1
  v_cndmask_b32 v33, v23, v22, vcc
  s_mul_i32 s53, s44, 288
  v_lshl_add_u32 v12, v24, 2, s53
  s_waitcnt vmcnt(18)
  v_lshlrev_b32 v58, 16, v52
  v_and_b32 v59, 0xffff0000, v52
  v_lshlrev_b32 v60, 16, v53
  v_and_b32 v61, 0xffff0000, v53
  v_lshlrev_b32 v62, 16, v54
  v_and_b32 v63, 0xffff0000, v54
  v_lshlrev_b32 v64, 16, v55
  v_and_b32 v65, 0xffff0000, v55
  v_lshlrev_b32 v66, 16, v56
  v_and_b32 v67, 0xffff0000, v56
  v_readfirstlane_b32 s62, v58
  s_nop 1
  v_subrev_f32 v36, s62, v58
  v_subrev_f32 v37, s62, v59
  v_subrev_f32 v38, s62, v60
  v_subrev_f32 v39, s62, v61
  v_subrev_f32 v40, s62, v62
  v_subrev_f32 v41, s62, v63
  v_subrev_f32 v42, s62, v64
  v_subrev_f32 v43, s62, v65
  v_subrev_f32 v44, s62, v66
  v_subrev_f32 v45, s62, v67
  v_cmp_gt_u32 vcc, 32, v1
  s_nop 1
  v_cndmask_b32 v44, 0, v44, vcc
  v_cndmask_b32 v45, 0, v45, vcc
  v_add_f32 v8, v36, v37
  v_mul_f32 v9, v36, v36
  v_fmac_f32 v9, v37, v37
  v_add_f32 v8, v8, v38
  v_fmac_f32 v9, v38, v38
  v_add_f32 v8, v8, v39
  v_fmac_f32 v9, v39, v39
  v_add_f32 v8, v8, v40
  v_fmac_f32 v9, v40, v40
  v_add_f32 v8, v8, v41
  v_fmac_f32 v9, v41, v41
  v_add_f32 v8, v8, v42
  v_fmac_f32 v9, v42, v42
  v_add_f32 v8, v8, v43
  v_fmac_f32 v9, v43, v43
  v_add_f32 v8, v8, v44
  v_fmac_f32 v9, v44, v44
  v_add_f32 v8, v8, v45
  v_fmac_f32 v9, v45, v45
  s_nop 0
  v_add_f32_dpp v8, v8, v8 quad_perm:[1,0,3,2] row_mask:0xf bank_mask:0xf
  v_add_f32_dpp v9, v9, v9 quad_perm:[1,0,3,2] row_mask:0xf bank_mask:0xf
  s_nop 0
  v_add_f32_dpp v8, v8, v8 quad_perm:[2,3,0,1] row_mask:0xf bank_mask:0xf
  v_add_f32_dpp v9, v9, v9 quad_perm:[2,3,0,1] row_mask:0xf bank_mask:0xf
  s_nop 0
  v_add_f32_dpp v8, v8, v8 row_half_mirror row_mask:0xf bank_mask:0xf
  v_add_f32_dpp v9, v9, v9 row_half_mirror row_mask:0xf bank_mask:0xf
  s_nop 0
  v_add_f32_dpp v8, v8, v8 row_mirror row_mask:0xf bank_mask:0xf
  v_add_f32_dpp v9, v9, v9 row_mirror row_mask:0xf bank_mask:0xf
  v_mov_b32 v10, v8
  v_mov_b32 v11, v9
  s_nop 0
  v_permlane16_swap_b32 v8, v10
  v_permlane16_swap_b32 v9, v11
  v_add_f32 v8, v8, v10
  v_add_f32 v9, v9, v11
  v_mov_b32 v10, v8
  v_mov_b32 v11, v9
  s_nop 0
  v_permlane32_swap_b32 v8, v10
  v_permlane32_swap_b32 v9, v11
  v_add_f32 v8, v8, v10
  v_add_f32 v9, v9, v11
  v_mul_f32 v8, 0x3ae38e39, v8
  v_mul_f32 v9, 0x3ae38e39, v9
  v_fma_f32 v9, -v8, v8, v9
  v_max_f32 v9, 0, v9
  v_add_f32 v8, s62, v8
  v_cvt_pk_bf16_f32 v68, 0, v8
  v_cvt_pk_bf16_f32 v9, 0, v9
  v_add_f32 v9, 0x3727c5ac, v9
  v_cvt_pk_bf16_f32 v9, 0, v9
  v_sqrt_f32 v9, v9
  s_nop 0
  v_cvt_pk_bf16_f32 v9, 0, v9
  v_rcp_f32 v69, v9
  v_sub_f32 v58, v58, v68
  v_sub_f32 v59, v59, v68
  v_sub_f32 v60, v60, v68
  v_sub_f32 v61, v61, v68
  v_sub_f32 v62, v62, v68
  v_sub_f32 v63, v63, v68
  v_sub_f32 v64, v64, v68
  v_sub_f32 v65, v65, v68
  v_sub_f32 v66, v66, v68
  v_sub_f32 v67, v67, v68
  v_cvt_pk_bf16_f32 v58, 0, v58
  v_cvt_pk_bf16_f32 v59, 0, v59
  v_cvt_pk_bf16_f32 v60, 0, v60
  v_cvt_pk_bf16_f32 v61, 0, v61
  v_cvt_pk_bf16_f32 v62, 0, v62
  v_cvt_pk_bf16_f32 v63, 0, v63
  v_cvt_pk_bf16_f32 v64, 0, v64
  v_cvt_pk_bf16_f32 v65, 0, v65
  v_cvt_pk_bf16_f32 v66, 0, v66
  v_cvt_pk_bf16_f32 v67, 0, v67
  v_mul_f32 v58, v58, v69
  v_mul_f32 v59, v59, v69
  v_mul_f32 v60, v60, v69
  v_mul_f32 v61, v61, v69
  v_mul_f32 v62, v62, v69
  v_mul_f32 v63, v63, v69
  v_mul_f32 v64, v64, v69
  v_mul_f32 v65, v65, v69
  v_mul_f32 v66, v66, v69
  v_mul_f32 v67, v67, v69
  v_cvt_pk_bf16_f32 v58, 0, v58
  v_cvt_pk_bf16_f32 v59, 0, v59
  v_cvt_pk_bf16_f32 v60, 0, v60
  v_cvt_pk_bf16_f32 v61, 0, v61
  v_cvt_pk_bf16_f32 v62, 0, v62
  v_cvt_pk_bf16_f32 v63, 0, v63
  v_cvt_pk_bf16_f32 v64, 0, v64
  v_cvt_pk_bf16_f32 v65, 0, v65
  v_cvt_pk_bf16_f32 v66, 0, v66
  v_cvt_pk_bf16_f32 v67, 0, v67
  v_cvt_pk_bf16_f32 v52, v58, v59
  v_cvt_pk_bf16_f32 v53, v60, v61
  v_cvt_pk_bf16_f32 v54, v62, v63
  v_cvt_pk_bf16_f32 v55, v64, v65
  v_cvt_pk_bf16_f32 v56, v66, v67
  ds_write_b32 v7, v52 offset:0
  ds_write_b32 v7, v53 offset:256
  ds_write_b32 v7, v54 offset:512
  ds_write_b32 v7, v55 offset:768
  s_mov_b32 exec_hi, 0
  ds_write_b32 v7, v56 offset:1024
  s_mov_b64 exec, -1
  s_waitcnt lgkmcnt(0)
  ds_read2_b32 v[160:161], v12 offset0:0 offset1:4
  ds_read2_b32 v[162:163], v12 offset0:8 offset1:12
  ds_read2_b32 v[164:165], v12 offset0:16 offset1:20
  ds_read2_b32 v[166:167], v12 offset0:24 offset1:28
  ds_read2_b32 v[168:169], v12 offset0:32 offset1:36
  ds_read2_b32 v[170:171], v12 offset0:40 offset1:44
  ds_read2_b32 v[172:173], v12 offset0:48 offset1:52
  ds_read2_b32 v[174:175], v12 offset0:56 offset1:60
  ds_read2_b32 v[176:177], v12 offset0:64 offset1:68
  s_waitcnt lgkmcnt(0)
  s_add_u32 s48, s49, 0x10001
  v_mov_b32 v6, s48
  s_lshl_b32 s53, s42, 13
  s_lshl_b32 s54, s44, 11
  s_add_u32 s53, s53, s54
  s_lshl_b32 s54, s45, 9
  s_add_u32 s53, s53, s54
  s_add_u32 s53, s53, 4096
  v_lshl_add_u32 v13, v24, 3, v26
  v_lshl_add_u32 v13, v13, 5, s53
  v_mov_b32 v37, v6
  v_mov_b32 v39, v6
  v_mov_b32 v41, v6
  v_mov_b32 v43, v6
  v_perm_b32 v144, v160, v160, v30
  v_perm_b32 v145, v160, v160, v31
  v_perm_b32 v146, v160, v160, v32
  v_perm_b32 v147, v160, v160, v33
  s_waitcnt vmcnt(17)
  s_nop 0
  v_mfma_f32_16x16x32_bf16 v[180:183], v[72:75], v[144:147], 0
  v_perm_b32 v148, v161, v161, v30
  v_perm_b32 v149, v161, v161, v31
  v_perm_b32 v150, v161, v161, v32
  v_perm_b32 v151, v161, v161, v33
  s_waitcnt vmcnt(16)
  s_nop 0
  v_mfma_f32_16x16x32_bf16 v[180:183], v[76:79], v[148:151], v[180:183]
  v_perm_b32 v152, v162, v162, v30
  v_perm_b32 v153, v162, v162, v31
  v_perm_b32 v154, v162, v162, v32
  v_perm_b32 v155, v162, v162, v33
  s_waitcnt vmcnt(15)
  s_nop 0
  v_mfma_f32_16x16x32_bf16 v[180:183], v[80:83], v[152:155], v[180:183]
  v_perm_b32 v156, v163, v163, v30
  v_perm_b32 v157, v163, v163, v31
  v_perm_b32 v158, v163, v163, v32
  v_perm_b32 v159, v163, v163, v33
  s_waitcnt vmcnt(14)
  s_nop 0
  v_mfma_f32_16x16x32_bf16 v[180:183], v[84:87], v[156:159], v[180:183]
  v_perm_b32 v144, v164, v164, v30
  v_perm_b32 v145, v164, v164, v31
  v_perm_b32 v146, v164, v164, v32
  v_perm_b32 v147, v164, v164, v33
  s_waitcnt vmcnt(13)
  s_nop 0
  v_mfma_f32_16x16x32_bf16 v[180:183], v[88:91], v[144:147], v[180:183]
  v_perm_b32 v148, v165, v165, v30
  v_perm_b32 v149, v165, v165, v31
  v_perm_b32 v150, v165, v165, v32
  v_perm_b32 v151, v165, v165, v33
  s_waitcnt vmcnt(12)
  s_nop 0
  v_mfma_f32_16x16x32_bf16 v[180:183], v[92:95], v[148:151], v[180:183]
  v_perm_b32 v152, v166, v166, v30
  v_perm_b32 v153, v166, v166, v31
  v_perm_b32 v154, v166, v166, v32
  v_perm_b32 v155, v166, v166, v33
  s_waitcnt vmcnt(11)
  s_nop 0
  v_mfma_f32_16x16x32_bf16 v[180:183], v[96:99], v[152:155], v[180:183]
  v_perm_b32 v156, v167, v167, v30
  v_perm_b32 v157, v167, v167, v31
  v_perm_b32 v158, v167, v167, v32
  v_perm_b32 v159, v167, v167, v33
  s_waitcnt vmcnt(10)
  s_nop 0
  v_mfma_f32_16x16x32_bf16 v[180:183], v[100:103], v[156:159], v[180:183]
  v_perm_b32 v144, v168, v168, v30
  v_perm_b32 v145, v168, v168, v31
  v_perm_b32 v146, v168, v168, v32
  v_perm_b32 v147, v168, v168, v33
  s_waitcnt vmcnt(9)
  s_nop 0
  v_mfma_f32_16x16x32_bf16 v[180:183], v[104:107], v[144:147], v[180:183]
  v_perm_b32 v148, v169, v169, v30
  v_perm_b32 v149, v169, v169, v31
  v_perm_b32 v150, v169, v169, v32
  v_perm_b32 v151, v169, v169, v33
  s_waitcnt vmcnt(8)
  s_nop 0
  v_mfma_f32_16x16x32_bf16 v[180:183], v[108:111], v[148:151], v[180:183]
  v_perm_b32 v152, v170, v170, v30
  v_perm_b32 v153, v170, v170, v31
  v_perm_b32 v154, v170, v170, v32
  v_perm_b32 v155, v170, v170, v33
  s_waitcnt vmcnt(7)
  s_nop 0
  v_mfma_f32_16x16x32_bf16 v[180:183], v[112:115], v[152:155], v[180:183]
  v_perm_b32 v156, v171, v171, v30
  v_perm_b32 v157, v171, v171, v31
  v_perm_b32 v158, v171, v171, v32
  v_perm_b32 v159, v171, v171, v33
  s_waitcnt vmcnt(6)
  s_nop 0
  v_mfma_f32_16x16x32_bf16 v[180:183], v[116:119], v[156:159], v[180:183]
  v_perm_b32 v144, v172, v172, v30
  v_perm_b32 v145, v172, v172, v31
  v_perm_b32 v146, v172, v172, v32
  v_perm_b32 v147, v172, v172, v33
  s_waitcnt vmcnt(5)
  s_nop 0
  v_mfma_f32_16x16x32_bf16 v[180:183], v[120:123], v[144:147], v[180:183]
  v_perm_b32 v148, v173, v173, v30
  v_perm_b32 v149, v173, v173, v31
  v_perm_b32 v150, v173, v173, v32
  v_perm_b32 v151, v173, v173, v33
  s_waitcnt vmcnt(4)
  s_nop 0
  v_mfma_f32_16x16x32_bf16 v[180:183], v[124:127], v[148:151], v[180:183]
  v_perm_b32 v152, v174, v174, v30
  v_perm_b32 v153, v174, v174, v31
  v_perm_b32 v154, v174, v174, v32
  v_perm_b32 v155, v174, v174, v33
  s_waitcnt vmcnt(3)
  s_nop 0
  v_mfma_f32_16x16x32_bf16 v[180:183], v[128:131], v[152:155], v[180:183]
  v_perm_b32 v156, v175, v175, v30
  v_perm_b32 v157, v175, v175, v31
  v_perm_b32 v158, v175, v175, v32
  v_perm_b32 v159, v175, v175, v33
  s_waitcnt vmcnt(2)
  s_nop 0
  v_mfma_f32_16x16x32_bf16 v[180:183], v[132:135], v[156:159], v[180:183]
  v_perm_b32 v144, v176, v176, v30
  v_perm_b32 v145, v176, v176, v31
  v_perm_b32 v146, v176, v176, v32
  v_perm_b32 v147, v176, v176, v33
  s_waitcnt vmcnt(1)
  s_nop 0
  v_mfma_f32_16x16x32_bf16 v[180:183], v[136:139], v[144:147], v[180:183]
  v_perm_b32 v148, v177, v177, v30
  v_perm_b32 v149, v177, v177, v31
  v_perm_b32 v150, v177, v177, v32
  v_perm_b32 v151, v177, v177, v33
  s_waitcnt vmcnt(0)
  s_nop 0
  v_mfma_f32_16x16x32_bf16 v[180:183], v[140:143], v[148:151], v[180:183]
  s_nop 7
  v_mov_b32_dpp v14, v180 row_ror:8 row_mask:0xf bank_mask:0xf
  v_mov_b32_dpp v15, v181 row_ror:8 row_mask:0xf bank_mask:0xf
  v_mov_b32_dpp v16, v182 row_ror:8 row_mask:0xf bank_mask:0xf
  v_mov_b32_dpp v17, v183 row_ror:8 row_mask:0xf bank_mask:0xf
  v_permlane32_swap_b32 v14, v18
  v_permlane32_swap_b32 v15, v19
  v_permlane32_swap_b32 v16, v20
  v_permlane32_swap_b32 v17, v21
  v_add_f32 v36, v180, v18
  v_add_f32 v38, v181, v19
  v_add_f32 v40, v182, v20
  v_add_f32 v42, v183, v21
  s_mov_b64 exec, 0x00ff00ff
  global_store_dwordx4 v13, v[36:39], s[40:41] offset:0
  global_store_dwordx4 v13, v[40:43], s[40:41] offset:16
  global_store_dwordx4 v13, v[36:39], s[60:61] offset:0 sc1
  global_store_dwordx4 v13, v[40:43], s[60:61] offset:16 sc1
  s_mov_b64 exec, -1
  s_branch L_W
L_M:
  s_and_b32 s53, s2, 3
  s_mul_i32 s53, s53, 2304
  s_sub_u32 s58, s47, 1
  s_mul_i32 s54, s58, 768
  s_add_u32 s53, s53, s54
  v_mul_u32_u24 v120, 12, v1
  v_add_u32 v120, s53, v120
  s_lshr_b32 s53, s2, 2
  s_mul_i32 s53, s53, 18
  v_min_u32 v121, 8, v1
  v_lshl_add_u32 v121, v121, 1, s53
  s_lshl_b32 s53, s42, 13
  s_add_u32 s53, s53, 4096
  v_lshl_add_u32 v8, v24, 11, s53
  v_lshl_add_u32 v8, v27, 4, v8
  s_mul_i32 s54, s58, 3
  s_add_u32 s53, s54, 0
  s_min_u32 s53, s53, 7
  s_lshl_b32 s53, s53, 8
  v_add_u32 v122, s53, v8
  s_add_u32 s53, s54, 1
  s_min_u32 s53, s53, 7
  s_lshl_b32 s53, s53, 8
  v_add_u32 v123, s53, v8
  s_add_u32 s53, s54, 2
  s_min_u32 s53, s53, 7
  s_lshl_b32 s53, s53, 8
  v_add_u32 v124, s53, v8
  s_waitcnt lgkmcnt(0)
  s_load_dword s49, s[40:41], 0
  s_add_u32 s60, s40, 2097152
  s_addc_u32 s61, s41, 0
  v_add_u32 v70, 1024, v7
  v_min_u32 v70, 1148, v70
  global_load_dword v52, v7, s[16:17] offset:0
  global_load_dword v53, v7, s[16:17] offset:256
  global_load_dword v54, v7, s[16:17] offset:512
  global_load_dword v55, v7, s[16:17] offset:768
  global_load_dword v56, v70, s[16:17]
  global_load_ushort v57, v121, s[16:17]
  global_load_dwordx3 v[72:74], v120, s[28:29]
  global_load_dwordx3 v[76:78], v120, s[30:31]
  global_load_dwordx3 v[80:82], v120, s[32:33]
  v_mov_b32 v126, 0
  s_cmp_eq_u32 s47, 2
  s_cbranch_scc1 L_t2
  s_cmp_eq_u32 s47, 3
  s_cbranch_scc1 L_t3
  v_mov_b32 v127, s46
  global_load_dword v126, v127, s[20:21] nt
  s_lshl_b32 s53, s50, 6
  s_mul_i32 s53, s53, 1152
  s_min_u32 s53, s53, 4718588
  v_mov_b32 v127, s53
  global_load_dword v126, v127, s[24:25] nt
  s_branch L_tdone
L_t2:
  global_load_dword v126, v126, s[40:41] offset:256 sc1
  global_load_dword v127, v126, s[60:61] offset:256 sc1
  s_branch L_tdone
L_t3:
  global_load_ushort v126, v126, s[36:37]
  v_mov_b32 v127, 0
  global_load_ushort v127, v127, s[34:35]
L_tdone:
  s_mul_i32 s53, s43, 3
  s_add_u32 s53, s53, s58
  s_lshl_b32 s53, s53, 10
  v_lshl_add_u32 v125, v1, 4, s53
  v_min_u32 v125, L_codeend-L_pc-16, v125
  global_load_dwordx4 v[232:235], v125, s[92:93]
  s_barrier
  v_and_b32 v21, 1, v1
  v_lshlrev_b32 v21, 4, v21
  v_mul_u32_u24 v22, 0x202, v25
  v_add_u32 v22, 0x100, v22
  v_lshlrev_b32 v22, v21, v22
  v_sub_u32 v21, 16, v21
  v_mov_b32 v23, 0xc0c
  v_lshlrev_b32 v23, v21, v23
  v_or_b32 v22, v22, v23
  v_mov_b32 v23, 0x0c0c0c0c
  v_bfe_u32 v20, v1, 1, 2
  v_cmp_eq_u32 vcc, 0, v20
  s_nop 1
  v_cndmask_b32 v30, v23, v22, vcc
  v_cmp_eq_u32 vcc, 1, v20
  s_nop 1
  v_cndmask_b32 v31, v23, v22, vcc
  v_cmp_eq_u32 vcc, 2, v20
  s_nop 1
  v_cndmask_b32 v32, v23, v22, vcc
  v_cmp_eq_u32 vcc, 3, v20
  s_nop 1
  v_cndmask_b32 v33, v23, v22, vcc
  s_waitcnt vmcnt(6)
  v_lshlrev_b32 v57, 16, v57
  v_lshlrev_b32 v58, 16, v52
  v_and_b32 v59, 0xffff0000, v52
  v_lshlrev_b32 v60, 16, v53
  v_and_b32 v61, 0xffff0000, v53
  v_lshlrev_b32 v62, 16, v54
  v_and_b32 v63, 0xffff0000, v54
  v_lshlrev_b32 v64, 16, v55
  v_and_b32 v65, 0xffff0000, v55
  v_lshlrev_b32 v66, 16, v56
  v_and_b32 v67, 0xffff0000, v56
  v_readfirstlane_b32 s62, v58
  s_nop 1
  v_subrev_f32 v36, s62, v58
  v_subrev_f32 v37, s62, v59
  v_subrev_f32 v38, s62, v60
  v_subrev_f32 v39, s62, v61
  v_subrev_f32 v40, s62, v62
  v_subrev_f32 v41, s62, v63
  v_subrev_f32 v42, s62, v64
  v_subrev_f32 v43, s62, v65
  v_subrev_f32 v44, s62, v66
  v_subrev_f32 v45, s62, v67
  v_cmp_gt_u32 vcc, 32, v1
  s_nop 1
  v_cndmask_b32 v44, 0, v44, vcc
  v_cndmask_b32 v45, 0, v45, vcc
  v_add_f32 v8, v36, v37
  v_mul_f32 v9, v36, v36
  v_fmac_f32 v9, v37, v37
  v_add_f32 v8, v8, v38
  v_fmac_f32 v9, v38, v38
  v_add_f32 v8, v8, v39
  v_fmac_f32 v9, v39, v39
  v_add_f32 v8, v8, v40
  v_fmac_f32 v9, v40, v40
  v_add_f32 v8, v8, v41
  v_fmac_f32 v9, v41, v41
  v_add_f32 v8, v8, v42
  v_fmac_f32 v9, v42, v42
  v_add_f32 v8, v8, v43
  v_fmac_f32 v9, v43, v43
  v_add_f32 v8, v8, v44
  v_fmac_f32 v9, v44, v44
  v_add_f32 v8, v8, v45
  v_fmac_f32 v9, v45, v45
  s_nop 0
  v_add_f32_dpp v8, v8, v8 quad_perm:[1,0,3,2] row_mask:0xf bank_mask:0xf
  v_add_f32_dpp v9, v9, v9 quad_perm:[1,0,3,2] row_mask:0xf bank_mask:0xf
  s_nop 0
  v_add_f32_dpp v8, v8, v8 quad_perm:[2,3,0,1] row_mask:0xf bank_mask:0xf
  v_add_f32_dpp v9, v9, v9 quad_perm:[2,3,0,1] row_mask:0xf bank_mask:0xf
  s_nop 0
  v_add_f32_dpp v8, v8, v8 row_half_mirror row_mask:0xf bank_mask:0xf
  v_add_f32_dpp v9, v9, v9 row_half_mirror row_mask:0xf bank_mask:0xf
  s_nop 0
  v_add_f32_dpp v8, v8, v8 row_mirror row_mask:0xf bank_mask:0xf
  v_add_f32_dpp v9, v9, v9 row_mirror row_mask:0xf bank_mask:0xf
  v_mov_b32 v10, v8
  v_mov_b32 v11, v9
  s_nop 0
  v_permlane16_swap_b32 v8, v10
  v_permlane16_swap_b32 v9, v11
  v_add_f32 v8, v8, v10
  v_add_f32 v9, v9, v11
  v_mov_b32 v10, v8
  v_mov_b32 v11, v9
  s_nop 0
  v_permlane32_swap_b32 v8, v10
  v_permlane32_swap_b32 v9, v11
  v_add_f32 v8, v8, v10
  v_add_f32 v9, v9, v11
  v_mul_f32 v8, 0x3ae38e39, v8
  v_mul_f32 v9, 0x3ae38e39, v9
  v_fma_f32 v9, -v8, v8, v9
  v_max_f32 v9, 0, v9
  v_add_f32 v8, s62, v8
  v_cvt_pk_bf16_f32 v68, 0, v8
  v_cvt_pk_bf16_f32 v9, 0, v9
  v_add_f32 v9, 0x3727c5ac, v9
  v_cvt_pk_bf16_f32 v9, 0, v9
  v_sqrt_f32 v9, v9
  s_nop 0
  v_cvt_pk_bf16_f32 v9, 0, v9
  v_rcp_f32 v69, v9
  v_sub_f32 v58, v58, v68
  v_sub_f32 v59, v59, v68
  v_sub_f32 v60, v60, v68
  v_sub_f32 v61, v61, v68
  v_sub_f32 v62, v62, v68
  v_sub_f32 v63, v63, v68
  v_sub_f32 v64, v64, v68
  v_sub_f32 v65, v65, v68
  v_sub_f32 v66, v66, v68
  v_sub_f32 v67, v67, v68
  v_sub_f32 v57, v57, v68
  v_cvt_pk_bf16_f32 v58, 0, v58
  v_cvt_pk_bf16_f32 v59, 0, v59
  v_cvt_pk_bf16_f32 v60, 0, v60
  v_cvt_pk_bf16_f32 v61, 0, v61
  v_cvt_pk_bf16_f32 v62, 0, v62
  v_cvt_pk_bf16_f32 v63, 0, v63
  v_cvt_pk_bf16_f32 v64, 0, v64
  v_cvt_pk_bf16_f32 v65, 0, v65
  v_cvt_pk_bf16_f32 v66, 0, v66
  v_cvt_pk_bf16_f32 v67, 0, v67
  v_cvt_pk_bf16_f32 v57, 0, v57
  v_mul_f32 v58, v58, v69
  v_mul_f32 v59, v59, v69
  v_mul_f32 v60, v60, v69
  v_mul_f32 v61, v61, v69
  v_mul_f32 v62, v62, v69
  v_mul_f32 v63, v63, v69
  v_mul_f32 v64, v64, v69
  v_mul_f32 v65, v65, v69
  v_mul_f32 v66, v66, v69
  v_mul_f32 v67, v67, v69
  v_mul_f32 v57, v57, v69
  v_cvt_pk_bf16_f32 v58, 0, v58
  v_cvt_pk_bf16_f32 v59, 0, v59
  v_cvt_pk_bf16_f32 v60, 0, v60
  v_cvt_pk_bf16_f32 v61, 0, v61
  v_cvt_pk_bf16_f32 v62, 0, v62
  v_cvt_pk_bf16_f32 v63, 0, v63
  v_cvt_pk_bf16_f32 v64, 0, v64
  v_cvt_pk_bf16_f32 v65, 0, v65
  v_cvt_pk_bf16_f32 v66, 0, v66
  v_cvt_pk_bf16_f32 v67, 0, v67
  v_cvt_pk_bf16_f32 v57, 0, v57
  v_readfirstlane_b32 s62, v58
  s_nop 1
  v_subrev_f32 v36, s62, v58
  v_subrev_f32 v37, s62, v59
  v_subrev_f32 v38, s62, v60
  v_subrev_f32 v39, s62, v61
  v_subrev_f32 v40, s62, v62
  v_subrev_f32 v41, s62, v63
  v_subrev_f32 v42, s62, v64
  v_subrev_f32 v43, s62, v65
  v_subrev_f32 v44, s62, v66
  v_subrev_f32 v45, s62, v67
  v_cmp_gt_u32 vcc, 32, v1
  s_nop 1
  v_cndmask_b32 v44, 0, v44, vcc
  v_cndmask_b32 v45, 0, v45, vcc
  v_add_f32 v8, v36, v37
  v_mul_f32 v9, v36, v36
  v_fmac_f32 v9, v37, v37
  v_add_f32 v8, v8, v38
  v_fmac_f32 v9, v38, v38
  v_add_f32 v8, v8, v39
  v_fmac_f32 v9, v39, v39
  v_add_f32 v8, v8, v40
  v_fmac_f32 v9, v40, v40
  v_add_f32 v8, v8, v41
  v_fmac_f32 v9, v41, v41
  v_add_f32 v8, v8, v42
  v_fmac_f32 v9, v42, v42
  v_add_f32 v8, v8, v43
  v_fmac_f32 v9, v43, v43
  v_add_f32 v8, v8, v44
  v_fmac_f32 v9, v44, v44
  v_add_f32 v8, v8, v45
  v_fmac_f32 v9, v45, v45
  s_nop 0
  v_add_f32_dpp v8, v8, v8 quad_perm:[1,0,3,2] row_mask:0xf bank_mask:0xf
  v_add_f32_dpp v9, v9, v9 quad_perm:[1,0,3,2] row_mask:0xf bank_mask:0xf
  s_nop 0
  v_add_f32_dpp v8, v8, v8 quad_perm:[2,3,0,1] row_mask:0xf bank_mask:0xf
  v_add_f32_dpp v9, v9, v9 quad_perm:[2,3,0,1] row_mask:0xf bank_mask:0xf
  s_nop 0
  v_add_f32_dpp v8, v8, v8 row_half_mirror row_mask:0xf bank_mask:0xf
  v_add_f32_dpp v9, v9, v9 row_half_mirror row_mask:0xf bank_mask:0xf
  s_nop 0
  v_add_f32_dpp v8, v8, v8 row_mirror row_mask:0xf bank_mask:0xf
  v_add_f32_dpp v9, v9, v9 row_mirror row_mask:0xf bank_mask:0xf
  v_mov_b32 v10, v8
  v_mov_b32 v11, v9
  s_nop 0
  v_permlane16_swap_b32 v8, v10
  v_permlane16_swap_b32 v9, v11
  v_add_f32 v8, v8, v10
  v_add_f32 v9, v9, v11
  v_mov_b32 v10, v8
  v_mov_b32 v11, v9
  s_nop 0
  v_permlane32_swap_b32 v8, v10
  v_permlane32_swap_b32 v9, v11
  v_add_f32 v8, v8, v10
  v_add_f32 v9, v9, v11
  v_mul_f32 v8, 0x3ae38e39, v8
  v_mul_f32 v9, 0x3ae38e39, v9
  v_fma_f32 v9, -v8, v8, v9
  v_max_f32 v9, 0, v9
  v_add_f32 v8, s62, v8
  v_cvt_pk_bf16_f32 v22, 0, v8
  v_cvt_pk_bf16_f32 v9, 0, v9
  v_add_f32 v9, 0x3727c5ac, v9
  v_cvt_pk_bf16_f32 v9, 0, v9
  v_sqrt_f32 v9, v9
  s_nop 0
  v_cvt_pk_bf16_f32 v9, 0, v9
  v_rcp_f32 v23, v9
  v_sub_f32 v57, v57, v22
  v_cvt_pk_bf16_f32 v57, 0, v57
  v_mul_f32 v57, v57, v23
  v_cvt_pk_bf16_f32 v57, 0, v57
  s_nop 0
  v_readlane_b32 s4, v57, 0
  v_readlane_b32 s5, v57, 1
  v_readlane_b32 s6, v57, 2
  v_readlane_b32 s7, v57, 3
  v_readlane_b32 s8, v57, 4
  v_readlane_b32 s9, v57, 5
  v_readlane_b32 s10, v57, 6
  v_readlane_b32 s11, v57, 7
  v_readlane_b32 s12, v57, 8
  s_mov_b32 s14, 0xbdd2d3e8
  s_mov_b32 s15, 0xc0135761
  v_mov_b32 v96, 0
  v_mov_b32 v97, 0
  v_mov_b32 v98, 0
  v_mov_b32 v99, 0
  v_mov_b32 v100, 0
  v_mov_b32 v101, 0
  v_mov_b32 v102, 0
  v_mov_b32 v103, 0
  v_mov_b32 v104, 0
  s_waitcnt lgkmcnt(0)
  s_add_u32 s48, s49, 0x10001
  v_mov_b32 v6, s48
  s_waitcnt vmcnt(3)
  v_lshlrev_b32 v84, 16, v72
  v_and_b32 v85, 0xffff0000, v72
  v_lshlrev_b32 v90, 16, v76
  v_and_b32 v91, 0xffff0000, v76
  v_lshlrev_b32 v86, 16, v73
  v_and_b32 v87, 0xffff0000, v73
  v_lshlrev_b32 v92, 16, v77
  v_and_b32 v93, 0xffff0000, v77
  v_lshlrev_b32 v88, 16, v74
  v_and_b32 v89, 0xffff0000, v74
  v_lshlrev_b32 v94, 16, v78
  v_and_b32 v95, 0xffff0000, v78
  v_pk_mul_f32 v[36:37], v[84:85], s[4:5] op_sel_hi:[1,0]
  v_pk_mul_f32 v[42:43], v[84:85], s[4:5] op_sel:[0,1] op_sel_hi:[1,1]
  v_cvt_pk_bf16_f32 v36, 0, v36
  v_cvt_pk_bf16_f32 v42, 0, v42
  v_cvt_pk_bf16_f32 v37, 0, v37
  v_cvt_pk_bf16_f32 v43, 0, v43
  v_pk_add_f32 v[38:39], v[36:37], v[90:91]
  v_pk_add_f32 v[44:45], v[42:43], v[90:91]
  v_cvt_pk_bf16_f32 v38, 0, v38
  v_cvt_pk_bf16_f32 v44, 0, v44
  v_cvt_pk_bf16_f32 v39, 0, v39
  v_cvt_pk_bf16_f32 v45, 0, v45
  v_pk_mul_f32 v[36:37], v[38:39], v[38:39]
  v_pk_mul_f32 v[42:43], v[44:45], v[44:45]
  v_pk_fma_f32 v[36:37], v[36:37], s[14:15], s[14:15] op_sel:[0,0,1] op_sel_hi:[1,0,1]
  v_pk_fma_f32 v[42:43], v[42:43], s[14:15], s[14:15] op_sel:[0,0,1] op_sel_hi:[1,0,1]
  v_pk_mul_f32 v[36:37], v[36:37], v[38:39]
  v_pk_mul_f32 v[42:43], v[42:43], v[44:45]
  v_exp_f32 v40, v36
  v_exp_f32 v46, v42
  v_exp_f32 v41, v37
  v_exp_f32 v47, v43
  v_pk_add_f32 v[40:41], v[40:41], 1.0 op_sel_hi:[1,0]
  v_pk_add_f32 v[46:47], v[46:47], 1.0 op_sel_hi:[1,0]
  v_rcp_f32 v40, v40
  v_rcp_f32 v46, v46
  v_rcp_f32 v41, v41
  v_rcp_f32 v47, v47
  v_pk_mul_f32 v[38:39], v[38:39], v[40:41]
  v_pk_mul_f32 v[44:45], v[44:45], v[46:47]
  v_cvt_pk_bf16_f32 v38, v38, v39
  v_cvt_pk_bf16_f32 v44, v44, v45
  v_dot2_f32_bf16 v96, v38, v80, v96
  v_dot2_f32_bf16 v97, v44, v80, v97
  v_pk_mul_f32 v[36:37], v[84:85], s[6:7] op_sel_hi:[1,0]
  v_pk_mul_f32 v[42:43], v[84:85], s[6:7] op_sel:[0,1] op_sel_hi:[1,1]
  v_cvt_pk_bf16_f32 v36, 0, v36
  v_cvt_pk_bf16_f32 v42, 0, v42
  v_cvt_pk_bf16_f32 v37, 0, v37
  v_cvt_pk_bf16_f32 v43, 0, v43
  v_pk_add_f32 v[38:39], v[36:37], v[90:91]
  v_pk_add_f32 v[44:45], v[42:43], v[90:91]
  v_cvt_pk_bf16_f32 v38, 0, v38
  v_cvt_pk_bf16_f32 v44, 0, v44
  v_cvt_pk_bf16_f32 v39, 0, v39
  v_cvt_pk_bf16_f32 v45, 0, v45
  v_pk_mul_f32 v[36:37], v[38:39], v[38:39]
  v_pk_mul_f32 v[42:43], v[44:45], v[44:45]
  v_pk_fma_f32 v[36:37], v[36:37], s[14:15], s[14:15] op_sel:[0,0,1] op_sel_hi:[1,0,1]
  v_pk_fma_f32 v[42:43], v[42:43], s[14:15], s[14:15] op_sel:[0,0,1] op_sel_hi:[1,0,1]
  v_pk_mul_f32 v[36:37], v[36:37], v[38:39]
  v_pk_mul_f32 v[42:43], v[42:43], v[44:45]
  v_exp_f32 v40, v36
  v_exp_f32 v46, v42
  v_exp_f32 v41, v37
  v_exp_f32 v47, v43
  v_pk_add_f32 v[40:41], v[40:41], 1.0 op_sel_hi:[1,0]
  v_pk_add_f32 v[46:47], v[46:47], 1.0 op_sel_hi:[1,0]
  v_rcp_f32 v40, v40
  v_rcp_f32 v46, v46
  v_rcp_f32 v41, v41
  v_rcp_f32 v47, v47
  v_pk_mul_f32 v[38:39], v[38:39], v[40:41]
  v_pk_mul_f32 v[44:45], v[44:45], v[46:47]
  v_cvt_pk_bf16_f32 v38, v38, v39
  v_cvt_pk_bf16_f32 v44, v44, v45
  v_dot2_f32_bf16 v98, v38, v80, v98
  v_dot2_f32_bf16 v99, v44, v80, v99
  v_pk_mul_f32 v[36:37], v[84:85], s[8:9] op_sel_hi:[1,0]
  v_pk_mul_f32 v[42:43], v[84:85], s[8:9] op_sel:[0,1] op_sel_hi:[1,1]
  v_cvt_pk_bf16_f32 v36, 0, v36
  v_cvt_pk_bf16_f32 v42, 0, v42
  v_cvt_pk_bf16_f32 v37, 0, v37
  v_cvt_pk_bf16_f32 v43, 0, v43
  v_pk_add_f32 v[38:39], v[36:37], v[90:91]
  v_pk_add_f32 v[44:45], v[42:43], v[90:91]
  v_cvt_pk_bf16_f32 v38, 0, v38
  v_cvt_pk_bf16_f32 v44, 0, v44
  v_cvt_pk_bf16_f32 v39, 0, v39
  v_cvt_pk_bf16_f32 v45, 0, v45
  v_pk_mul_f32 v[36:37], v[38:39], v[38:39]
  v_pk_mul_f32 v[42:43], v[44:45], v[44:45]
  v_pk_fma_f32 v[36:37], v[36:37], s[14:15], s[14:15] op_sel:[0,0,1] op_sel_hi:[1,0,1]
  v_pk_fma_f32 v[42:43], v[42:43], s[14:15], s[14:15] op_sel:[0,0,1] op_sel_hi:[1,0,1]
  v_pk_mul_f32 v[36:37], v[36:37], v[38:39]
  v_pk_mul_f32 v[42:43], v[42:43], v[44:45]
  v_exp_f32 v40, v36
  v_exp_f32 v46, v42
  v_exp_f32 v41, v37
  v_exp_f32 v47, v43
  v_pk_add_f32 v[40:41], v[40:41], 1.0 op_sel_hi:[1,0]
  v_pk_add_f32 v[46:47], v[46:47], 1.0 op_sel_hi:[1,0]
  v_rcp_f32 v40, v40
  v_rcp_f32 v46, v46
  v_rcp_f32 v41, v41
  v_rcp_f32 v47, v47
  v_pk_mul_f32 v[38:39], v[38:39], v[40:41]
  v_pk_mul_f32 v[44:45], v[44:45], v[46:47]
  v_cvt_pk_bf16_f32 v38, v38, v39
  v_cvt_pk_bf16_f32 v44, v44, v45
  v_dot2_f32_bf16 v100, v38, v80, v100
  v_dot2_f32_bf16 v101, v44, v80, v101
  v_pk_mul_f32 v[36:37], v[84:85], s[10:11] op_sel_hi:[1,0]
  v_pk_mul_f32 v[42:43], v[84:85], s[10:11] op_sel:[0,1] op_sel_hi:[1,1]
  v_cvt_pk_bf16_f32 v36, 0, v36
  v_cvt_pk_bf16_f32 v42, 0, v42
  v_cvt_pk_bf16_f32 v37, 0, v37
  v_cvt_pk_bf16_f32 v43, 0, v43
  v_pk_add_f32 v[38:39], v[36:37], v[90:91]
  v_pk_add_f32 v[44:45], v[42:43], v[90:91]
  v_cvt_pk_bf16_f32 v38, 0, v38
  v_cvt_pk_bf16_f32 v44, 0, v44
  v_cvt_pk_bf16_f32 v39, 0, v39
  v_cvt_pk_bf16_f32 v45, 0, v45
  v_pk_mul_f32 v[36:37], v[38:39], v[38:39]
  v_pk_mul_f32 v[42:43], v[44:45], v[44:45]
  v_pk_fma_f32 v[36:37], v[36:37], s[14:15], s[14:15] op_sel:[0,0,1] op_sel_hi:[1,0,1]
  v_pk_fma_f32 v[42:43], v[42:43], s[14:15], s[14:15] op_sel:[0,0,1] op_sel_hi:[1,0,1]
  v_pk_mul_f32 v[36:37], v[36:37], v[38:39]
  v_pk_mul_f32 v[42:43], v[42:43], v[44:45]
  v_exp_f32 v40, v36
  v_exp_f32 v46, v42
  v_exp_f32 v41, v37
  v_exp_f32 v47, v43
  v_pk_add_f32 v[40:41], v[40:41], 1.0 op_sel_hi:[1,0]
  v_pk_add_f32 v[46:47], v[46:47], 1.0 op_sel_hi:[1,0]
  v_rcp_f32 v40, v40
  v_rcp_f32 v46, v46
  v_rcp_f32 v41, v41
  v_rcp_f32 v47, v47
  v_pk_mul_f32 v[38:39], v[38:39], v[40:41]
  v_pk_mul_f32 v[44:45], v[44:45], v[46:47]
  v_cvt_pk_bf16_f32 v38, v38, v39
  v_cvt_pk_bf16_f32 v44, v44, v45
  v_dot2_f32_bf16 v102, v38, v80, v102
  v_dot2_f32_bf16 v103, v44, v80, v103
  v_pk_mul_f32 v[36:37], v[84:85], s[12:13] op_sel_hi:[1,0]
  v_pk_mul_f32 v[42:43], v[86:87], s[4:5] op_sel_hi:[1,0]
  v_cvt_pk_bf16_f32 v36, 0, v36
  v_cvt_pk_bf16_f32 v42, 0, v42
  v_cvt_pk_bf16_f32 v37, 0, v37
  v_cvt_pk_bf16_f32 v43, 0, v43
  v_pk_add_f32 v[38:39], v[36:37], v[90:91]
  v_pk_add_f32 v[44:45], v[42:43], v[92:93]
  v_cvt_pk_bf16_f32 v38, 0, v38
  v_cvt_pk_bf16_f32 v44, 0, v44
  v_cvt_pk_bf16_f32 v39, 0, v39
  v_cvt_pk_bf16_f32 v45, 0, v45
  v_pk_mul_f32 v[36:37], v[38:39], v[38:39]
  v_pk_mul_f32 v[42:43], v[44:45], v[44:45]
  v_pk_fma_f32 v[36:37], v[36:37], s[14:15], s[14:15] op_sel:[0,0,1] op_sel_hi:[1,0,1]
  v_pk_fma_f32 v[42:43], v[42:43], s[14:15], s[14:15] op_sel:[0,0,1] op_sel_hi:[1,0,1]
  v_pk_mul_f32 v[36:37], v[36:37], v[38:39]
  v_pk_mul_f32 v[42:43], v[42:43], v[44:45]
  v_exp_f32 v40, v36
  v_exp_f32 v46, v42
  v_exp_f32 v41, v37
  v_exp_f32 v47, v43
  v_pk_add_f32 v[40:41], v[40:41], 1.0 op_sel_hi:[1,0]
  v_pk_add_f32 v[46:47], v[46:47], 1.0 op_sel_hi:[1,0]
  v_rcp_f32 v40, v40
  v_rcp_f32 v46, v46
  v_rcp_f32 v41, v41
  v_rcp_f32 v47, v47
  v_pk_mul_f32 v[38:39], v[38:39], v[40:41]
  v_pk_mul_f32 v[44:45], v[44:45], v[46:47]
  v_cvt_pk_bf16_f32 v38, v38, v39
  v_cvt_pk_bf16_f32 v44, v44, v45
  v_dot2_f32_bf16 v104, v38, v80, v104
  v_dot2_f32_bf16 v96, v44, v81, v96
  v_pk_mul_f32 v[36:37], v[86:87], s[4:5] op_sel:[0,1] op_sel_hi:[1,1]
  v_pk_mul_f32 v[42:43], v[86:87], s[6:7] op_sel_hi:[1,0]
  v_cvt_pk_bf16_f32 v36, 0, v36
  v_cvt_pk_bf16_f32 v42, 0, v42
  v_cvt_pk_bf16_f32 v37, 0, v37
  v_cvt_pk_bf16_f32 v43, 0, v43
  v_pk_add_f32 v[38:39], v[36:37], v[92:93]
  v_pk_add_f32 v[44:45], v[42:43], v[92:93]
  v_cvt_pk_bf16_f32 v38, 0, v38
  v_cvt_pk_bf16_f32 v44, 0, v44
  v_cvt_pk_bf16_f32 v39, 0, v39
  v_cvt_pk_bf16_f32 v45, 0, v45
  v_pk_mul_f32 v[36:37], v[38:39], v[38:39]
  v_pk_mul_f32 v[42:43], v[44:45], v[44:45]
  v_pk_fma_f32 v[36:37], v[36:37], s[14:15], s[14:15] op_sel:[0,0,1] op_sel_hi:[1,0,1]
  v_pk_fma_f32 v[42:43], v[42:43], s[14:15], s[14:15] op_sel:[0,0,1] op_sel_hi:[1,0,1]
  v_pk_mul_f32 v[36:37], v[36:37], v[38:39]
  v_pk_mul_f32 v[42:43], v[42:43], v[44:45]
  v_exp_f32 v40, v36
  v_exp_f32 v46, v42
  v_exp_f32 v41, v37
  v_exp_f32 v47, v43
  v_pk_add_f32 v[40:41], v[40:41], 1.0 op_sel_hi:[1,0]
  v_pk_add_f32 v[46:47], v[46:47], 1.0 op_sel_hi:[1,0]
  v_rcp_f32 v40, v40
  v_rcp_f32 v46, v46
  v_rcp_f32 v41, v41
  v_rcp_f32 v47, v47
  v_pk_mul_f32 v[38:39], v[38:39], v[40:41]
  v_pk_mul_f32 v[44:45], v[44:45], v[46:47]
  v_cvt_pk_bf16_f32 v38, v38, v39
  v_cvt_pk_bf16_f32 v44, v44, v45
  v_dot2_f32_bf16 v97, v38, v81, v97
  v_dot2_f32_bf16 v98, v44, v81, v98
  v_pk_mul_f32 v[36:37], v[86:87], s[6:7] op_sel:[0,1] op_sel_hi:[1,1]
  v_pk_mul_f32 v[42:43], v[86:87], s[8:9] op_sel_hi:[1,0]
  v_cvt_pk_bf16_f32 v36, 0, v36
  v_cvt_pk_bf16_f32 v42, 0, v42
  v_cvt_pk_bf16_f32 v37, 0, v37
  v_cvt_pk_bf16_f32 v43, 0, v43
  v_pk_add_f32 v[38:39], v[36:37], v[92:93]
  v_pk_add_f32 v[44:45], v[42:43], v[92:93]
  v_cvt_pk_bf16_f32 v38, 0, v38
  v_cvt_pk_bf16_f32 v44, 0, v44
  v_cvt_pk_bf16_f32 v39, 0, v39
  v_cvt_pk_bf16_f32 v45, 0, v45
  v_pk_mul_f32 v[36:37], v[38:39], v[38:39]
  v_pk_mul_f32 v[42:43], v[44:45], v[44:45]
  v_pk_fma_f32 v[36:37], v[36:37], s[14:15], s[14:15] op_sel:[0,0,1] op_sel_hi:[1,0,1]
  v_pk_fma_f32 v[42:43], v[42:43], s[14:15], s[14:15] op_sel:[0,0,1] op_sel_hi:[1,0,1]
  v_pk_mul_f32 v[36:37], v[36:37], v[38:39]
  v_pk_mul_f32 v[42:43], v[42:43], v[44:45]
  v_exp_f32 v40, v36
  v_exp_f32 v46, v42
  v_exp_f32 v41, v37
  v_exp_f32 v47, v43
  v_pk_add_f32 v[40:41], v[40:41], 1.0 op_sel_hi:[1,0]
  v_pk_add_f32 v[46:47], v[46:47], 1.0 op_sel_hi:[1,0]
  v_rcp_f32 v40, v40
  v_rcp_f32 v46, v46
  v_rcp_f32 v41, v41
  v_rcp_f32 v47, v47
  v_pk_mul_f32 v[38:39], v[38:39], v[40:41]
  v_pk_mul_f32 v[44:45], v[44:45], v[46:47]
  v_cvt_pk_bf16_f32 v38, v38, v39
  v_cvt_pk_bf16_f32 v44, v44, v45
  v_dot2_f32_bf16 v99, v38, v81, v99
  v_dot2_f32_bf16 v100, v44, v81, v100
  v_pk_mul_f32 v[36:37], v[86:87], s[8:9] op_sel:[0,1] op_sel_hi:[1,1]
  v_pk_mul_f32 v[42:43], v[86:87], s[10:11] op_sel_hi:[1,0]
  v_cvt_pk_bf16_f32 v36, 0, v36
  v_cvt_pk_bf16_f32 v42, 0, v42
  v_cvt_pk_bf16_f32 v37, 0, v37
  v_cvt_pk_bf16_f32 v43, 0, v43
  v_pk_add_f32 v[38:39], v[36:37], v[92:93]
  v_pk_add_f32 v[44:45], v[42:43], v[92:93]
  v_cvt_pk_bf16_f32 v38, 0, v38
  v_cvt_pk_bf16_f32 v44, 0, v44
  v_cvt_pk_bf16_f32 v39, 0, v39
  v_cvt_pk_bf16_f32 v45, 0, v45
  v_pk_mul_f32 v[36:37], v[38:39], v[38:39]
  v_pk_mul_f32 v[42:43], v[44:45], v[44:45]
  v_pk_fma_f32 v[36:37], v[36:37], s[14:15], s[14:15] op_sel:[0,0,1] op_sel_hi:[1,0,1]
  v_pk_fma_f32 v[42:43], v[42:43], s[14:15], s[14:15] op_sel:[0,0,1] op_sel_hi:[1,0,1]
  v_pk_mul_f32 v[36:37], v[36:37], v[38:39]
  v_pk_mul_f32 v[42:43], v[42:43], v[44:45]
  v_exp_f32 v40, v36
  v_exp_f32 v46, v42
  v_exp_f32 v41, v37
  v_exp_f32 v47, v43
  v_pk_add_f32 v[40:41], v[40:41], 1.0 op_sel_hi:[1,0]
  v_pk_add_f32 v[46:47], v[46:47], 1.0 op_sel_hi:[1,0]
  v_rcp_f32 v40, v40
  v_rcp_f32 v46, v46
  v_rcp_f32 v41, v41
  v_rcp_f32 v47, v47
  v_pk_mul_f32 v[38:39], v[38:39], v[40:41]
  v_pk_mul_f32 v[44:45], v[44:45], v[46:47]
  v_cvt_pk_bf16_f32 v38, v38, v39
  v_cvt_pk_bf16_f32 v44, v44, v45
  v_dot2_f32_bf16 v101, v38, v81, v101
  v_dot2_f32_bf16 v102, v44, v81, v102
  v_pk_mul_f32 v[36:37], v[86:87], s[10:11] op_sel:[0,1] op_sel_hi:[1,1]
  v_pk_mul_f32 v[42:43], v[86:87], s[12:13] op_sel_hi:[1,0]
  v_cvt_pk_bf16_f32 v36, 0, v36
  v_cvt_pk_bf16_f32 v42, 0, v42
  v_cvt_pk_bf16_f32 v37, 0, v37
  v_cvt_pk_bf16_f32 v43, 0, v43
  v_pk_add_f32 v[38:39], v[36:37], v[92:93]
  v_pk_add_f32 v[44:45], v[42:43], v[92:93]
  v_cvt_pk_bf16_f32 v38, 0, v38
  v_cvt_pk_bf16_f32 v44, 0, v44
  v_cvt_pk_bf16_f32 v39, 0, v39
  v_cvt_pk_bf16_f32 v45, 0, v45
  v_pk_mul_f32 v[36:37], v[38:39], v[38:39]
  v_pk_mul_f32 v[42:43], v[44:45], v[44:45]
  v_pk_fma_f32 v[36:37], v[36:37], s[14:15], s[14:15] op_sel:[0,0,1] op_sel_hi:[1,0,1]
  v_pk_fma_f32 v[42:43], v[42:43], s[14:15], s[14:15] op_sel:[0,0,1] op_sel_hi:[1,0,1]
  v_pk_mul_f32 v[36:37], v[36:37], v[38:39]
  v_pk_mul_f32 v[42:43], v[42:43], v[44:45]
  v_exp_f32 v40, v36
  v_exp_f32 v46, v42
  v_exp_f32 v41, v37
  v_exp_f32 v47, v43
  v_pk_add_f32 v[40:41], v[40:41], 1.0 op_sel_hi:[1,0]
  v_pk_add_f32 v[46:47], v[46:47], 1.0 op_sel_hi:[1,0]
  v_rcp_f32 v40, v40
  v_rcp_f32 v46, v46
  v_rcp_f32 v41, v41
  v_rcp_f32 v47, v47
  v_pk_mul_f32 v[38:39], v[38:39], v[40:41]
  v_pk_mul_f32 v[44:45], v[44:45], v[46:47]
  v_cvt_pk_bf16_f32 v38, v38, v39
  v_cvt_pk_bf16_f32 v44, v44, v45
  v_dot2_f32_bf16 v103, v38, v81, v103
  v_dot2_f32_bf16 v104, v44, v81, v104
  v_pk_mul_f32 v[36:37], v[88:89], s[4:5] op_sel_hi:[1,0]
  v_pk_mul_f32 v[42:43], v[88:89], s[4:5] op_sel:[0,1] op_sel_hi:[1,1]
  v_cvt_pk_bf16_f32 v36, 0, v36
  v_cvt_pk_bf16_f32 v42, 0, v42
  v_cvt_pk_bf16_f32 v37, 0, v37
  v_cvt_pk_bf16_f32 v43, 0, v43
  v_pk_add_f32 v[38:39], v[36:37], v[94:95]
  v_pk_add_f32 v[44:45], v[42:43], v[94:95]
  v_cvt_pk_bf16_f32 v38, 0, v38
  v_cvt_pk_bf16_f32 v44, 0, v44
  v_cvt_pk_bf16_f32 v39, 0, v39
  v_cvt_pk_bf16_f32 v45, 0, v45
  v_pk_mul_f32 v[36:37], v[38:39], v[38:39]
  v_pk_mul_f32 v[42:43], v[44:45], v[44:45]
  v_pk_fma_f32 v[36:37], v[36:37], s[14:15], s[14:15] op_sel:[0,0,1] op_sel_hi:[1,0,1]
  v_pk_fma_f32 v[42:43], v[42:43], s[14:15], s[14:15] op_sel:[0,0,1] op_sel_hi:[1,0,1]
  v_pk_mul_f32 v[36:37], v[36:37], v[38:39]
  v_pk_mul_f32 v[42:43], v[42:43], v[44:45]
  v_exp_f32 v40, v36
  v_exp_f32 v46, v42
  v_exp_f32 v41, v37
  v_exp_f32 v47, v43
  v_pk_add_f32 v[40:41], v[40:41], 1.0 op_sel_hi:[1,0]
  v_pk_add_f32 v[46:47], v[46:47], 1.0 op_sel_hi:[1,0]
  v_rcp_f32 v40, v40
  v_rcp_f32 v46, v46
  v_rcp_f32 v41, v41
  v_rcp_f32 v47, v47
  v_pk_mul_f32 v[38:39], v[38:39], v[40:41]
  v_pk_mul_f32 v[44:45], v[44:45], v[46:47]
  v_cvt_pk_bf16_f32 v38, v38, v39
  v_cvt_pk_bf16_f32 v44, v44, v45
  v_dot2_f32_bf16 v96, v38, v82, v96
  v_dot2_f32_bf16 v97, v44, v82, v97
  v_pk_mul_f32 v[36:37], v[88:89], s[6:7] op_sel_hi:[1,0]
  v_pk_mul_f32 v[42:43], v[88:89], s[6:7] op_sel:[0,1] op_sel_hi:[1,1]
  v_cvt_pk_bf16_f32 v36, 0, v36
  v_cvt_pk_bf16_f32 v42, 0, v42
  v_cvt_pk_bf16_f32 v37, 0, v37
  v_cvt_pk_bf16_f32 v43, 0, v43
  v_pk_add_f32 v[38:39], v[36:37], v[94:95]
  v_pk_add_f32 v[44:45], v[42:43], v[94:95]
  v_cvt_pk_bf16_f32 v38, 0, v38
  v_cvt_pk_bf16_f32 v44, 0, v44
  v_cvt_pk_bf16_f32 v39, 0, v39
  v_cvt_pk_bf16_f32 v45, 0, v45
  v_pk_mul_f32 v[36:37], v[38:39], v[38:39]
  v_pk_mul_f32 v[42:43], v[44:45], v[44:45]
  v_pk_fma_f32 v[36:37], v[36:37], s[14:15], s[14:15] op_sel:[0,0,1] op_sel_hi:[1,0,1]
  v_pk_fma_f32 v[42:43], v[42:43], s[14:15], s[14:15] op_sel:[0,0,1] op_sel_hi:[1,0,1]
  v_pk_mul_f32 v[36:37], v[36:37], v[38:39]
  v_pk_mul_f32 v[42:43], v[42:43], v[44:45]
  v_exp_f32 v40, v36
  v_exp_f32 v46, v42
  v_exp_f32 v41, v37
  v_exp_f32 v47, v43
  v_pk_add_f32 v[40:41], v[40:41], 1.0 op_sel_hi:[1,0]
  v_pk_add_f32 v[46:47], v[46:47], 1.0 op_sel_hi:[1,0]
  v_rcp_f32 v40, v40
  v_rcp_f32 v46, v46
  v_rcp_f32 v41, v41
  v_rcp_f32 v47, v47
  v_pk_mul_f32 v[38:39], v[38:39], v[40:41]
  v_pk_mul_f32 v[44:45], v[44:45], v[46:47]
  v_cvt_pk_bf16_f32 v38, v38, v39
  v_cvt_pk_bf16_f32 v44, v44, v45
  v_dot2_f32_bf16 v98, v38, v82, v98
  v_dot2_f32_bf16 v99, v44, v82, v99
  v_pk_mul_f32 v[36:37], v[88:89], s[8:9] op_sel_hi:[1,0]
  v_pk_mul_f32 v[42:43], v[88:89], s[8:9] op_sel:[0,1] op_sel_hi:[1,1]
  v_cvt_pk_bf16_f32 v36, 0, v36
  v_cvt_pk_bf16_f32 v42, 0, v42
  v_cvt_pk_bf16_f32 v37, 0, v37
  v_cvt_pk_bf16_f32 v43, 0, v43
  v_pk_add_f32 v[38:39], v[36:37], v[94:95]
  v_pk_add_f32 v[44:45], v[42:43], v[94:95]
  v_cvt_pk_bf16_f32 v38, 0, v38
  v_cvt_pk_bf16_f32 v44, 0, v44
  v_cvt_pk_bf16_f32 v39, 0, v39
  v_cvt_pk_bf16_f32 v45, 0, v45
  v_pk_mul_f32 v[36:37], v[38:39], v[38:39]
  v_pk_mul_f32 v[42:43], v[44:45], v[44:45]
  v_pk_fma_f32 v[36:37], v[36:37], s[14:15], s[14:15] op_sel:[0,0,1] op_sel_hi:[1,0,1]
  v_pk_fma_f32 v[42:43], v[42:43], s[14:15], s[14:15] op_sel:[0,0,1] op_sel_hi:[1,0,1]
  v_pk_mul_f32 v[36:37], v[36:37], v[38:39]
  v_pk_mul_f32 v[42:43], v[42:43], v[44:45]
  v_exp_f32 v40, v36
  v_exp_f32 v46, v42
  v_exp_f32 v41, v37
  v_exp_f32 v47, v43
  v_pk_add_f32 v[40:41], v[40:41], 1.0 op_sel_hi:[1,0]
  v_pk_add_f32 v[46:47], v[46:47], 1.0 op_sel_hi:[1,0]
  v_rcp_f32 v40, v40
  v_rcp_f32 v46, v46
  v_rcp_f32 v41, v41
  v_rcp_f32 v47, v47
  v_pk_mul_f32 v[38:39], v[38:39], v[40:41]
  v_pk_mul_f32 v[44:45], v[44:45], v[46:47]
  v_cvt_pk_bf16_f32 v38, v38, v39
  v_cvt_pk_bf16_f32 v44, v44, v45
  v_dot2_f32_bf16 v100, v38, v82, v100
  v_dot2_f32_bf16 v101, v44, v82, v101
  v_pk_mul_f32 v[36:37], v[88:89], s[10:11] op_sel_hi:[1,0]
  v_pk_mul_f32 v[42:43], v[88:89], s[10:11] op_sel:[0,1] op_sel_hi:[1,1]
  v_cvt_pk_bf16_f32 v36, 0, v36
  v_cvt_pk_bf16_f32 v42, 0, v42
  v_cvt_pk_bf16_f32 v37, 0, v37
  v_cvt_pk_bf16_f32 v43, 0, v43
  v_pk_add_f32 v[38:39], v[36:37], v[94:95]
  v_pk_add_f32 v[44:45], v[42:43], v[94:95]
  v_cvt_pk_bf16_f32 v38, 0, v38
  v_cvt_pk_bf16_f32 v44, 0, v44
  v_cvt_pk_bf16_f32 v39, 0, v39
  v_cvt_pk_bf16_f32 v45, 0, v45
  v_pk_mul_f32 v[36:37], v[38:39], v[38:39]
  v_pk_mul_f32 v[42:43], v[44:45], v[44:45]
  v_pk_fma_f32 v[36:37], v[36:37], s[14:15], s[14:15] op_sel:[0,0,1] op_sel_hi:[1,0,1]
  v_pk_fma_f32 v[42:43], v[42:43], s[14:15], s[14:15] op_sel:[0,0,1] op_sel_hi:[1,0,1]
  v_pk_mul_f32 v[36:37], v[36:37], v[38:39]
  v_pk_mul_f32 v[42:43], v[42:43], v[44:45]
  v_exp_f32 v40, v36
  v_exp_f32 v46, v42
  v_exp_f32 v41, v37
  v_exp_f32 v47, v43
  v_pk_add_f32 v[40:41], v[40:41], 1.0 op_sel_hi:[1,0]
  v_pk_add_f32 v[46:47], v[46:47], 1.0 op_sel_hi:[1,0]
  v_rcp_f32 v40, v40
  v_rcp_f32 v46, v46
  v_rcp_f32 v41, v41
  v_rcp_f32 v47, v47
  v_pk_mul_f32 v[38:39], v[38:39], v[40:41]
  v_pk_mul_f32 v[44:45], v[44:45], v[46:47]
  v_cvt_pk_bf16_f32 v38, v38, v39
  v_cvt_pk_bf16_f32 v44, v44, v45
  v_dot2_f32_bf16 v102, v38, v82, v102
  v_dot2_f32_bf16 v103, v44, v82, v103
  v_pk_mul_f32 v[36:37], v[88:89], s[12:13] op_sel_hi:[1,0]
  v_cvt_pk_bf16_f32 v36, 0, v36
  v_cvt_pk_bf16_f32 v37, 0, v37
  v_pk_add_f32 v[38:39], v[36:37], v[94:95]
  v_cvt_pk_bf16_f32 v38, 0, v38
  v_cvt_pk_bf16_f32 v39, 0, v39
  v_pk_mul_f32 v[36:37], v[38:39], v[38:39]
  v_pk_fma_f32 v[36:37], v[36:37], s[14:15], s[14:15] op_sel:[0,0,1] op_sel_hi:[1,0,1]
  v_pk_mul_f32 v[36:37], v[36:37], v[38:39]
  v_exp_f32 v40, v36
  v_exp_f32 v41, v37
  s_nop 0
  v_pk_add_f32 v[40:41], v[40:41], 1.0 op_sel_hi:[1,0]
  v_rcp_f32 v40, v40
  v_rcp_f32 v41, v41
  s_nop 0
  v_pk_mul_f32 v[38:39], v[38:39], v[40:41]
  v_cvt_pk_bf16_f32 v38, v38, v39
  v_dot2_f32_bf16 v104, v38, v82, v104
  s_mul_i32 s53, s58, 2304
  v_add_u32 v8, s53, v7
  ds_write_b32 v8, v96 offset:5888
  ds_write_b32 v8, v97 offset:6144
  ds_write_b32 v8, v98 offset:6400
  ds_write_b32 v8, v99 offset:6656
  ds_write_b32 v8, v100 offset:6912
  ds_write_b32 v8, v101 offset:7168
  ds_write_b32 v8, v102 offset:7424
  ds_write_b32 v8, v103 offset:7680
  ds_write_b32 v8, v104 offset:7936
  v_lshrrev_b32 v9, 2, v1
  v_min_u32 v9, 8, v9
  v_and_b32 v10, 3, v1
  v_lshlrev_b32 v10, 6, v10
  v_lshl_add_u32 v10, v9, 8, v10
  v_add_u32 v10, s53, v10
  s_lshr_b32 s53, s2, 2
  s_mul_i32 s53, s53, 1152
  s_and_b32 s54, s2, 3
  s_mul_i32 s54, s54, 3
  s_add_u32 s54, s54, s58
  s_lshl_b32 s54, s54, 3
  s_add_u32 s53, s53, s54
  s_add_u32 s53, s53, 135168
  v_lshl_add_u32 v11, v9, 7, s53
  s_waitcnt lgkmcnt(0)
  ds_read_b128 v[36:39], v10 offset:5888
  ds_read_b128 v[40:43], v10 offset:5904
  ds_read_b128 v[44:47], v10 offset:5920
  ds_read_b128 v[48:51], v10 offset:5936
  s_waitcnt lgkmcnt(0)
  v_add_f32 v36, v36, v44
  v_add_f32 v37, v37, v45
  v_add_f32 v38, v38, v46
  v_add_f32 v39, v39, v47
  v_add_f32 v40, v40, v48
  v_add_f32 v41, v41, v49
  v_add_f32 v42, v42, v50
  v_add_f32 v43, v43, v51
  v_add_f32 v36, v36, v40
  v_add_f32 v37, v37, v41
  v_add_f32 v38, v38, v42
  v_add_f32 v39, v39, v43
  v_add_f32 v36, v36, v38
  v_add_f32 v37, v37, v39
  v_add_f32 v36, v36, v37
  s_nop 1
  v_add_f32_dpp v36, v36, v36 quad_perm:[1,0,3,2] row_mask:0xf bank_mask:0xf
  s_nop 1
  v_add_f32_dpp v36, v36, v36 quad_perm:[2,3,0,1] row_mask:0xf bank_mask:0xf
  v_mov_b32 v37, v6
  s_mov_b32 exec_lo, 0x11111111
  s_mov_b32 exec_hi, 1
  s_mov_b64 exec, -1
  v_mov_b32 v128, v36
  v_mov_b32 v129, v6
  v_mov_b32 v130, v11
  global_load_dwordx4 v[108:111], v122, s[40:41] sc1
  global_load_dwordx4 v[112:115], v123, s[40:41] sc1
  global_load_dwordx4 v[116:119], v124, s[40:41] sc1
  s_movk_i32 s55, 0
  s_waitcnt vmcnt(0)
L_qchk:
  v_xor_b32 v12, v6, v109
  v_xor_b32 v16, v6, v111
  v_or_b32 v12, v12, v16
  v_xor_b32 v13, v6, v113
  v_xor_b32 v17, v6, v115
  v_or_b32 v13, v13, v17
  v_xor_b32 v14, v6, v117
  v_xor_b32 v18, v6, v119
  v_or_b32 v14, v14, v18
  v_or3_b32 v12, v12, v13, v14
  v_cmp_ne_u32 vcc, 0, v12
  s_cmp_eq_u64 vcc, 0
  s_cbranch_scc1 L_qok
  s_add_u32 s55, s55, 1
  s_cmp_gt_u32 s55, 200000
  s_cbranch_scc1 L_qok
  s_cmp_lg_u32 s55, 16
  s_cbranch_scc1 L_qre
  v_add_u32 v122, 2097152, v122
  v_add_u32 v123, 2097152, v123
  v_add_u32 v124, 2097152, v124
L_qre:
  global_load_dwordx4 v[108:111], v122, s[40:41] sc1
  global_load_dwordx4 v[112:115], v123, s[40:41] sc1
  global_load_dwordx4 v[116:119], v124, s[40:41] sc1
  s_waitcnt vmcnt(0)
  s_branch L_qchk
L_qok:
  s_mov_b32 exec_lo, 0x11111111
  s_mov_b32 exec_hi, 1
  global_store_dwordx2 v130, v[128:129], s[40:41] sc1
  s_mov_b64 exec, -1
  v_mov_b32 v36, v108
  v_mov_b32 v37, v110
  v_mov_b32 v38, v112
  v_mov_b32 v39, v114
  v_mov_b32 v40, v116
  v_mov_b32 v41, v118
  v_permlane16_swap_b32 v108, v36
  v_permlane16_swap_b32 v110, v37
  v_permlane16_swap_b32 v112, v38
  v_permlane16_swap_b32 v114, v39
  v_permlane16_swap_b32 v116, v40
  v_permlane16_swap_b32 v118, v41
  v_add_f32 v108, v108, v36
  v_add_f32 v110, v110, v37
  v_add_f32 v112, v112, v38
  v_add_f32 v114, v114, v39
  v_add_f32 v116, v116, v40
  v_add_f32 v118, v118, v41
  v_mov_b32 v36, v108
  v_mov_b32 v37, v110
  v_mov_b32 v38, v112
  v_mov_b32 v39, v114
  v_mov_b32 v40, v116
  v_mov_b32 v41, v118
  v_permlane32_swap_b32 v108, v36
  v_permlane32_swap_b32 v110, v37
  v_permlane32_swap_b32 v112, v38
  v_permlane32_swap_b32 v114, v39
  v_permlane32_swap_b32 v116, v40
  v_permlane32_swap_b32 v118, v41
  v_add_f32 v108, v108, v36
  v_add_f32 v110, v110, v37
  v_add_f32 v112, v112, v38
  v_add_f32 v114, v114, v39
  v_add_f32 v116, v116, v40
  v_add_f32 v118, v118, v41
  v_cvt_pk_bf16_f32 v108, v108, v110
  v_cvt_pk_bf16_f32 v112, v112, v114
  v_cvt_pk_bf16_f32 v116, v116, v118
  s_mul_i32 s54, s58, 3
  v_and_b32 v9, 1, v1
  v_lshlrev_b32 v9, 5, v9
  v_bfe_u32 v10, v1, 1, 3
  v_lshl_add_u32 v9, v10, 1, v9
  s_mov_b64 exec, 0xffff
  s_add_u32 s53, s54, 0
  s_min_u32 s53, s53, 7
  s_lshl_b32 s53, s53, 6
  v_add_u32 v8, s53, v9
  ds_write_b16 v8, v108 offset:1152
  ds_write_b16_d16_hi v8, v108 offset:1168
  s_add_u32 s53, s54, 1
  s_min_u32 s53, s53, 7
  s_lshl_b32 s53, s53, 6
  v_add_u32 v8, s53, v9
  ds_write_b16 v8, v112 offset:1152
  ds_write_b16_d16_hi v8, v112 offset:1168
  s_add_u32 s53, s54, 2
  s_min_u32 s53, s53, 7
  s_lshl_b32 s53, s53, 6
  v_add_u32 v8, s53, v9
  ds_write_b16 v8, v116 offset:1152
  ds_write_b16_d16_hi v8, v116 offset:1168
  s_mov_b64 exec, -1
  s_waitcnt lgkmcnt(0)
L_W:
  s_barrier
  s_cmp_ge_u32 s43, 12
  s_cbranch_scc1 L_Wnowo
  v_lshl_add_u32 v152, v28, 4, v29
  s_lshl_b32 s53, s50, 6
  v_add_u32 v152, s53, v152
  s_movk_i32 s53, 1152
  v_mul_lo_u32 v152, v152, s53
  s_mul_i32 s53, s51, 384
  v_lshl_add_u32 v8, v26, 4, s53
  v_add_u32 v152, v152, v8
  v_add_u32 v153, 9216, v152
  global_load_dwordx4 v[128:131], v152, s[24:25] offset:0 nt
  global_load_dwordx4 v[132:135], v152, s[24:25] offset:128 nt
  global_load_dwordx4 v[136:139], v152, s[24:25] offset:256 nt
  global_load_dwordx4 v[140:143], v153, s[24:25] offset:0 nt
  global_load_dwordx4 v[144:147], v153, s[24:25] offset:128 nt
  global_load_dwordx4 v[148:151], v153, s[24:25] offset:256 nt
L_Wnowo:
  s_lshl_b32 s53, s42, 15
  s_and_b32 s54, s50, 3
  s_lshl_b32 s54, s54, 9
  s_add_u32 s53, s53, s54
  s_add_u32 s53, s53, 327680
  v_lshl_add_u32 v154, v27, 11, s53
  v_lshl_add_u32 v154, v28, 7, v154
  v_lshl_add_u32 v154, v24, 4, v154
  s_mul_i32 s53, s51, 98304
  s_lshl_b32 s54, s50, 7
  s_add_u32 s53, s53, s54
  s_add_u32 s53, s53, 851968
  v_lshrrev_b32 v11, 4, v0
  v_lshl_add_u32 v155, v11, 13, s53
  v_lshl_add_u32 v155, v27, 3, v155
  v_and_b32 v156, 1, v24
  v_lshl_add_u32 v156, v156, 5, v26
  v_mul_u32_u24 v156, 48, v156
  v_lshrrev_b32 v13, 5, v1
  v_lshl_add_u32 v13, v28, 1, v13
  v_lshl_add_u32 v156, v13, 2, v156
  v_and_b32 v159, 1, v28
  v_lshlrev_b32 v159, 4, v159
  v_lshrrev_b32 v157, 4, v1
  v_lshlrev_b32 v157, 6, v157
  v_and_b32 v15, 3, v1
  v_lshl_add_u32 v157, v15, 3, v157
  v_bfe_u32 v15, v1, 2, 2
  v_add_u32 v157, v157, v15
  v_lshl_add_u32 v157, v159, 1, v157
  v_lshlrev_b32 v157, 2, v157
  s_lshl_b32 s53, s42, 4
  s_add_u32 s53, s53, s43
  s_lshl_b32 s53, s53, 11
  s_add_u32 s53, s53, 327680
  v_lshl_add_u32 v158, v0, 4, s53
  s_cmp_gt_u32 s47, 1
  s_cbranch_scc1 L_nofac
  v_lshlrev_b32 v17, 2, v159
  s_movk_i32 s55, 0
L_wmpoll:
  ds_read_b128 v[36:39], v17 offset:1664
  ds_read_b128 v[40:43], v17 offset:1680
  ds_read_b128 v[44:47], v17 offset:1696
  ds_read_b128 v[48:51], v17 offset:1712
  s_waitcnt lgkmcnt(0)
  v_and_b32 v18, v38, v42
  v_and_b32 v19, v46, v50
  v_and_b32 v18, v18, v19
  v_cmp_ne_u32 vcc, 1, v18
  s_cmp_eq_u64 vcc, 0
  s_cbranch_scc1 L_wmok
  s_add_u32 s55, s55, 1
  s_cmp_gt_u32 s55, 4000000
  s_cbranch_scc1 L_wmok
  s_sleep 1
  s_branch L_wmpoll
L_wmok:
  ds_read_b64 v[36:37], v17 offset:1664
  ds_read_b64 v[40:41], v17 offset:1680
  ds_read_b64 v[44:45], v17 offset:1696
  ds_read_b64 v[48:49], v17 offset:1712
  s_waitcnt lgkmcnt(0)
  v_max3_f32 v8, v36, v40, v44
  v_max_f32 v8, v8, v48
  v_sub_f32 v168, v36, v8
  v_sub_f32 v169, v40, v8
  v_sub_f32 v170, v44, v8
  v_sub_f32 v171, v48, v8
  v_mul_f32 v168, 0x3fb8aa3b, v168
  v_mul_f32 v169, 0x3fb8aa3b, v169
  v_mul_f32 v170, 0x3fb8aa3b, v170
  v_mul_f32 v171, 0x3fb8aa3b, v171
  v_exp_f32 v168, v168
  v_exp_f32 v169, v169
  v_exp_f32 v170, v170
  v_exp_f32 v171, v171
  v_mul_f32 v9, v168, v37
  v_fmac_f32 v9, v169, v41
  v_fmac_f32 v9, v170, v45
  v_fmac_f32 v9, v171, v49
  v_rcp_f32 v160, v9
  v_log_f32 v161, v9
  s_nop 0
  v_fmac_f32 v161, 0x3fb8aa3b, v8
  v_mul_f32 v168, v168, v160
  v_mul_f32 v169, v169, v160
  v_mul_f32 v170, v170, v160
  v_mul_f32 v171, v171, v160
  s_mov_b32 s56, 0x07060100
  s_mov_b32 s57, 0x05040302
  v_perm_b32 v165, v161, v6, s56
  v_perm_b32 v167, v161, v6, s57
L_nofac:
  s_mov_b32 s56, 0x07060302
  s_mov_b32 s57, 0x05040100
  s_barrier
  s_cmp_gt_u32 s47, 1
  s_cbranch_scc1 L_noopub
  ds_read_b32 v36, v157 offset:1792
  ds_read_b32 v37, v157 offset:1808
  ds_read_b32 v38, v157 offset:2816
  ds_read_b32 v39, v157 offset:2832
  ds_read_b32 v40, v157 offset:3840
  ds_read_b32 v41, v157 offset:3856
  ds_read_b32 v42, v157 offset:4864
  ds_read_b32 v43, v157 offset:4880
  s_waitcnt lgkmcnt(0)
  v_mul_f32 v164, v168, v36
  v_mul_f32 v166, v168, v37
  v_fmac_f32 v164, v169, v38
  v_fmac_f32 v166, v169, v39
  v_fmac_f32 v164, v170, v40
  v_fmac_f32 v166, v170, v41
  v_fmac_f32 v164, v171, v42
  v_fmac_f32 v166, v171, v43
  global_store_dwordx4 v158, v[164:167], s[40:41]
  global_store_dwordx4 v158, v[164:167], s[60:61] sc1
L_noopub:
  s_cmp_ge_u32 s43, 12
  s_cbranch_scc1 L_RED
  s_movk_i32 s55, 0
L_opoll:
  global_load_dwordx4 v[192:195], v154, s[40:41] sc1
  global_load_dwordx4 v[196:199], v154, s[40:41] offset:64 sc1
  s_waitcnt vmcnt(0)
  v_perm_b32 v15, v195, v193, s57
  v_perm_b32 v16, v199, v197, s57
  v_xor_b32 v15, v15, v6
  v_xor_b32 v16, v16, v6
  v_or_b32 v15, v15, v16
  v_cmp_ne_u32 vcc, 0, v15
  s_cmp_eq_u64 vcc, 0
  s_cbranch_scc1 L_ook
  s_add_u32 s55, s55, 1
  s_cmp_gt_u32 s55, 200000
  s_cbranch_scc1 L_ook
  s_cmp_lg_u32 s55, 16
  s_cbranch_scc1 L_ore
  v_add_u32 v154, 2097152, v154
L_ore:
  s_sleep 1
  s_branch L_opoll
L_ook:
  v_perm_b32 v36, v193, v195, s56
  v_perm_b32 v37, v197, v199, s56
  v_mov_b32 v38, v36
  v_mov_b32 v39, v37
  s_nop 0
  v_max_f32_dpp v38, v38, v38 quad_perm:[1,0,3,2] row_mask:0xf bank_mask:0xf
  v_max_f32_dpp v39, v39, v39 quad_perm:[1,0,3,2] row_mask:0xf bank_mask:0xf
  s_nop 0
  v_max_f32_dpp v38, v38, v38 quad_perm:[2,3,0,1] row_mask:0xf bank_mask:0xf
  v_max_f32_dpp v39, v39, v39 quad_perm:[2,3,0,1] row_mask:0xf bank_mask:0xf
  s_nop 0
  v_max_f32_dpp v38, v38, v38 row_half_mirror row_mask:0xf bank_mask:0xf
  v_max_f32_dpp v39, v39, v39 row_half_mirror row_mask:0xf bank_mask:0xf
  s_nop 0
  v_max_f32_dpp v38, v38, v38 row_mirror row_mask:0xf bank_mask:0xf
  v_max_f32_dpp v39, v39, v39 row_mirror row_mask:0xf bank_mask:0xf
  v_sub_f32 v40, v36, v38
  v_sub_f32 v41, v37, v39
  v_exp_f32 v40, v40
  v_exp_f32 v41, v41
  v_mul_f32 v42, v40, v192
  v_mul_f32 v44, v40, v194
  v_mul_f32 v43, v41, v196
  v_mul_f32 v45, v41, v198
  v_add_f32_dpp v40, v40, v40 quad_perm:[1,0,3,2] row_mask:0xf bank_mask:0xf
  v_add_f32_dpp v41, v41, v41 quad_perm:[1,0,3,2] row_mask:0xf bank_mask:0xf
  v_add_f32_dpp v42, v42, v42 quad_perm:[1,0,3,2] row_mask:0xf bank_mask:0xf
  v_add_f32_dpp v43, v43, v43 quad_perm:[1,0,3,2] row_mask:0xf bank_mask:0xf
  v_add_f32_dpp v44, v44, v44 quad_perm:[1,0,3,2] row_mask:0xf bank_mask:0xf
  v_add_f32_dpp v45, v45, v45 quad_perm:[1,0,3,2] row_mask:0xf bank_mask:0xf
  v_add_f32_dpp v40, v40, v40 quad_perm:[2,3,0,1] row_mask:0xf bank_mask:0xf
  v_add_f32_dpp v41, v41, v41 quad_perm:[2,3,0,1] row_mask:0xf bank_mask:0xf
  v_add_f32_dpp v42, v42, v42 quad_perm:[2,3,0,1] row_mask:0xf bank_mask:0xf
  v_add_f32_dpp v43, v43, v43 quad_perm:[2,3,0,1] row_mask:0xf bank_mask:0xf
  v_add_f32_dpp v44, v44, v44 quad_perm:[2,3,0,1] row_mask:0xf bank_mask:0xf
  v_add_f32_dpp v45, v45, v45 quad_perm:[2,3,0,1] row_mask:0xf bank_mask:0xf
  v_add_f32_dpp v40, v40, v40 row_half_mirror row_mask:0xf bank_mask:0xf
  v_add_f32_dpp v41, v41, v41 row_half_mirror row_mask:0xf bank_mask:0xf
  v_add_f32_dpp v42, v42, v42 row_half_mirror row_mask:0xf bank_mask:0xf
  v_add_f32_dpp v43, v43, v43 row_half_mirror row_mask:0xf bank_mask:0xf
  v_add_f32_dpp v44, v44, v44 row_half_mirror row_mask:0xf bank_mask:0xf
  v_add_f32_dpp v45, v45, v45 row_half_mirror row_mask:0xf bank_mask:0xf
  v_add_f32_dpp v40, v40, v40 row_mirror row_mask:0xf bank_mask:0xf
  v_add_f32_dpp v41, v41, v41 row_mirror row_mask:0xf bank_mask:0xf
  v_add_f32_dpp v42, v42, v42 row_mirror row_mask:0xf bank_mask:0xf
  v_add_f32_dpp v43, v43, v43 row_mirror row_mask:0xf bank_mask:0xf
  v_add_f32_dpp v44, v44, v44 row_mirror row_mask:0xf bank_mask:0xf
  v_add_f32_dpp v45, v45, v45 row_mirror row_mask:0xf bank_mask:0xf
  v_rcp_f32 v40, v40
  v_rcp_f32 v41, v41
  v_mul_f32 v42, v42, v40
  v_mul_f32 v44, v44, v40
  v_mul_f32 v43, v43, v41
  v_mul_f32 v45, v45, v41
  v_cvt_pk_bf16_f32 v42, v42, v44
  v_cvt_pk_bf16_f32 v43, v43, v45
  v_perm_b32 v184, v42, v42, v30
  v_perm_b32 v185, v42, v42, v31
  v_perm_b32 v186, v42, v42, v32
  v_perm_b32 v187, v42, v42, v33
  v_perm_b32 v188, v43, v43, v30
  v_perm_b32 v189, v43, v43, v31
  v_perm_b32 v190, v43, v43, v32
  v_perm_b32 v191, v43, v43, v33
  v_mfma_f32_16x16x32_bf16 v[172:175], v[128:131], v[184:187], 0
  v_mfma_f32_16x16x32_bf16 v[176:179], v[132:135], v[184:187], 0
  v_mfma_f32_16x16x32_bf16 v[180:183], v[136:139], v[184:187], 0
  v_mfma_f32_16x16x32_bf16 v[172:175], v[140:143], v[188:191], v[172:175]
  v_mfma_f32_16x16x32_bf16 v[176:179], v[144:147], v[188:191], v[176:179]
  v_mfma_f32_16x16x32_bf16 v[180:183], v[148:151], v[188:191], v[180:183]
  s_mov_b32 exec_lo, 0x00ff00ff
  s_mov_b32 exec_hi, 0xff00ff00
  s_nop 3
  ds_write_b32 v156, v172 offset:12800
  ds_write_b32 v156, v173 offset:13184
  ds_write_b32 v156, v174 offset:13568
  ds_write_b32 v156, v175 offset:13952
  ds_write_b32 v156, v176 offset:15872
  ds_write_b32 v156, v177 offset:16256
  ds_write_b32 v156, v178 offset:16640
  ds_write_b32 v156, v179 offset:17024
  ds_write_b32 v156, v180 offset:18944
  ds_write_b32 v156, v181 offset:19328
  ds_write_b32 v156, v182 offset:19712
  ds_write_b32 v156, v183 offset:20096
  s_mov_b64 exec, -1
  v_mul_u32_u24 v10, 48, v0
  s_waitcnt lgkmcnt(0)
  s_barrier
  s_cmp_gt_u32 s47, 2
  s_cbranch_scc1 L_fin
  ds_read_b128 v[36:39], v10 offset:12800
  ds_read_b128 v[40:43], v10 offset:12816
  s_waitcnt lgkmcnt(0)
  v_add_f32 v36, v36, v40
  v_add_f32 v37, v37, v41
  v_add_f32 v38, v38, v42
  v_add_f32 v39, v39, v43
  v_add_f32 v36, v36, v38
  v_add_f32 v37, v37, v39
  v_add_f32 v36, v36, v37
  v_mov_b32 v37, v6
  global_store_dwordx2 v155, v[36:37], s[40:41] sc1
  s_branch L_fin
L_RED:
  s_cmp_ge_u32 s52, 36
  s_cbranch_scc1 L_fin
  s_lshl_b32 s53, s52, 13
  s_add_u32 s53, s53, 851968
  v_lshl_add_u32 v14, v0, 4, s53
  v_lshlrev_b32 v16, 6, v26
  v_lshl_add_u32 v16, v28, 2, v16
  s_cmp_lg_u32 s47, 0
  s_cbranch_scc1 L_noy
  v_lshrrev_b32 v9, 2, v1
  s_lshl_b32 s53, s52, 4
  v_add_u32 v9, s53, v9
  v_and_b32 v10, 3, v1
  v_lshlrev_b32 v8, 7, v9
  v_lshl_add_u32 v8, v10, 4, v8
  v_add_u32 v8, 135168, v8
  v_and_b32 v13, 1, v1
  v_lshlrev_b32 v13, 4, v13
  v_lshl_add_u32 v13, v9, 7, v13
  v_add_u32 v13, 135232, v13
  v_lshlrev_b32 v11, 1, v9
  global_load_ushort v12, v11, s[16:17]
  v_mov_b32 v17, 0
  global_load_ushort v17, v17, s[34:35]
  s_movk_i32 s55, 0
L_ypoll:
  global_load_dwordx4 v[36:39], v8, s[40:41] sc1
  global_load_dwordx4 v[40:43], v13, s[40:41] sc1
  s_waitcnt vmcnt(0)
  v_xor_b32 v18, v6, v37
  v_xor_b32 v19, v6, v39
  v_xor_b32 v20, v6, v41
  v_xor_b32 v21, v6, v43
  v_or3_b32 v18, v18, v19, v20
  v_or_b32 v18, v18, v21
  v_cmp_ne_u32 vcc, 0, v18
  s_cmp_eq_u64 vcc, 0
  s_cbranch_scc1 L_yok
  s_add_u32 s55, s55, 1
  s_cmp_gt_u32 s55, 200000
  s_cbranch_scc1 L_yok
  s_sleep 1
  s_branch L_ypoll
L_yok:
  v_add_f32 v36, v36, v38
  v_add_f32 v40, v40, v42
  v_cmp_gt_u32 vcc, 2, v10
  s_nop 1
  v_cndmask_b32 v40, 0, v40, vcc
  v_add_f32 v36, v36, v40
  s_nop 1
  v_add_f32_dpp v36, v36, v36 quad_perm:[1,0,3,2] row_mask:0xf bank_mask:0xf
  s_nop 1
  v_add_f32_dpp v36, v36, v36 quad_perm:[2,3,0,1] row_mask:0xf bank_mask:0xf
  v_cvt_pk_bf16_f32 v36, 0, v36
  v_lshlrev_b32 v17, 16, v17
  v_add_f32 v36, v36, v17
  v_cvt_pk_bf16_f32 v36, 0, v36
  v_mul_f32 v37, 0xbfb8aa3b, v36
  v_exp_f32 v37, v37
  s_nop 0
  v_add_f32 v37, 1.0, v37
  v_rcp_f32 v37, v37
  s_nop 0
  v_mul_f32 v36, v36, v37
  v_cvt_pk_bf16_f32 v36, 0, v36
  v_mov_b32 v15, v36
  v_lshlrev_b32 v12, 16, v12
  v_lshrrev_b32 v9, 2, v1
  v_lshlrev_b32 v9, 5, v9
  v_lshl_add_u32 v9, v10, 3, v9
L_noy:
  s_movk_i32 s55, 0
L_ppoll:
  global_load_dwordx4 v[44:47], v14, s[40:41] sc1
  s_waitcnt vmcnt(0)
  v_xor_b32 v18, v6, v45
  v_xor_b32 v19, v6, v47
  v_or_b32 v18, v18, v19
  v_cmp_ne_u32 vcc, 0, v18
  s_cmp_eq_u64 vcc, 0
  s_cbranch_scc1 L_pok
  s_add_u32 s55, s55, 1
  s_cmp_gt_u32 s55, 200000
  s_cbranch_scc1 L_pok
  s_sleep 1
  s_branch L_ppoll
L_pok:
  v_add_f32_dpp v44, v44, v44 row_ror:8 row_mask:0xf bank_mask:0xf
  v_add_f32_dpp v46, v46, v46 row_ror:8 row_mask:0xf bank_mask:0xf
  v_mov_b32 v45, v44
  v_mov_b32 v47, v46
  s_nop 0
  v_permlane16_swap_b32 v44, v45
  v_permlane16_swap_b32 v46, v47
  v_add_f32 v44, v44, v45
  v_add_f32 v46, v46, v47
  v_mov_b32 v45, v44
  v_mov_b32 v47, v46
  s_nop 0
  v_permlane32_swap_b32 v44, v45
  v_permlane32_swap_b32 v46, v47
  v_add_f32 v44, v44, v45
  v_add_f32 v46, v46, v47
  s_mov_b64 exec, 0xff
  ds_write_b32 v16, v44 offset:22016
  ds_write_b32 v16, v46 offset:22048
  s_mov_b64 exec, -1
  s_waitcnt lgkmcnt(0)
  s_barrier
  s_cmp_lg_u32 s47, 0
  s_cbranch_scc1 L_fin
  ds_read_b64 v[44:45], v9 offset:22016
  s_waitcnt lgkmcnt(0)
  v_add_f32 v44, v44, v45
  s_nop 1
  v_add_f32_dpp v44, v44, v44 quad_perm:[1,0,3,2] row_mask:0xf bank_mask:0xf
  s_nop 1
  v_add_f32_dpp v44, v44, v44 quad_perm:[2,3,0,1] row_mask:0xf bank_mask:0xf
  v_cvt_pk_bf16_f32 v44, 0, v44
  v_mul_f32 v44, v44, v15
  v_cvt_pk_bf16_f32 v44, 0, v44
  v_add_f32 v44, v44, v12
  v_cvt_pk_bf16_f32 v44, v44, v44
  s_mov_b32 exec_lo, 0x11111111
  s_mov_b32 exec_hi, 0x11111111
  global_store_short v11, v44, s[36:37]
  s_cmp_lg_u32 s52, 0
  s_cbranch_scc1 L_noep
  s_mov_b64 exec, 1
  v_mov_b32 v16, 0
  global_store_dword v16, v6, s[40:41] sc1
L_noep:
  s_mov_b64 exec, -1
  s_branch L_fin
L_S:
  s_sub_u32 s58, s47, 4
  s_lshl_b32 s53, s58, 14
  s_add_u32 s53, s53, s46
  s_sub_u32 s53, s53, 4096
  s_lshl_b32 s55, s58, 1
  s_add_u32 s55, s55, s43
  s_add_u32 s55, s55, s42
  s_and_b32 s55, s55, 7
  v_lshl_add_u32 v8, v26, 8, s53
  v_lshl_add_u32 v8, v25, 6, v8
  v_lshl_add_u32 v8, v24, 4, v8
  s_add_u32 s54, s55, 0
  s_and_b32 s54, s54, 7
  s_lshl_b32 s54, s54, 11
  v_add_u32 v180, s54, v8
  s_add_u32 s54, s55, 1
  s_and_b32 s54, s54, 7
  s_lshl_b32 s54, s54, 11
  v_add_u32 v181, s54, v8
  s_add_u32 s54, s55, 2
  s_and_b32 s54, s54, 7
  s_lshl_b32 s54, s54, 11
  v_add_u32 v182, s54, v8
  s_add_u32 s54, s55, 3
  s_and_b32 s54, s54, 7
  s_lshl_b32 s54, s54, 11
  v_add_u32 v183, s54, v8
  s_add_u32 s54, s55, 4
  s_and_b32 s54, s54, 7
  s_lshl_b32 s54, s54, 11
  v_add_u32 v184, s54, v8
  s_add_u32 s54, s55, 5
  s_and_b32 s54, s54, 7
  s_lshl_b32 s54, s54, 11
  v_add_u32 v185, s54, v8
  s_add_u32 s54, s55, 6
  s_and_b32 s54, s54, 7
  s_lshl_b32 s54, s54, 11
  v_add_u32 v186, s54, v8
  s_add_u32 s54, s55, 7
  s_and_b32 s54, s54, 7
  s_lshl_b32 s54, s54, 11
  v_add_u32 v187, s54, v8
  v_and_b32 v9, 1, v24
  v_lshl_add_u32 v9, v9, 10, s53
  v_lshl_add_u32 v9, v27, 4, v9
  v_lshrrev_b32 v10, 1, v24
  v_add_u32 v10, s55, v10
  v_add_u32 v11, 0, v10
  v_and_b32 v11, 7, v11
  v_lshl_add_u32 v188, v11, 11, v9
  v_add_u32 v11, 2, v10
  v_and_b32 v11, 7, v11
  v_lshl_add_u32 v189, v11, 11, v9
  v_add_u32 v11, 4, v10
  v_and_b32 v11, 7, v11
  v_lshl_add_u32 v190, v11, 11, v9
  v_add_u32 v11, 6, v10
  v_and_b32 v11, 7, v11
  v_lshl_add_u32 v191, v11, 11, v9
  s_waitcnt lgkmcnt(0)
  s_load_dword s49, s[40:41], 0
  s_add_u32 s60, s40, 2097152
  s_addc_u32 s61, s41, 0
  s_barrier
  global_load_dwordx4 v[52:55], v180, s[18:19] offset:0 nt
  global_load_dwordx4 v[56:59], v180, s[18:19] offset:128 nt
  global_load_dwordx4 v[60:63], v181, s[18:19] offset:0 nt
  global_load_dwordx4 v[64:67], v181, s[18:19] offset:128 nt
  global_load_dwordx4 v[68:71], v182, s[18:19] offset:0 nt
  global_load_dwordx4 v[72:75], v182, s[18:19] offset:128 nt
  global_load_dwordx4 v[76:79], v183, s[18:19] offset:0 nt
  s_waitcnt vmcnt(6)
  global_load_dwordx4 v[80:83], v183, s[18:19] offset:128 nt
  s_waitcnt vmcnt(6)
  global_load_dwordx4 v[84:87], v184, s[18:19] offset:0 nt
  s_waitcnt vmcnt(6)
  global_load_dwordx4 v[88:91], v184, s[18:19] offset:128 nt
  s_waitcnt vmcnt(15)
  global_load_dwordx4 v[92:95], v185, s[18:19] offset:0 nt
  s_waitcnt vmcnt(15)
  global_load_dwordx4 v[96:99], v185, s[18:19] offset:128 nt
  s_waitcnt vmcnt(15)
  global_load_dwordx4 v[100:103], v186, s[18:19] offset:0 nt
  s_waitcnt vmcnt(15)
  global_load_dwordx4 v[104:107], v186, s[18:19] offset:128 nt
  s_waitcnt vmcnt(15)
  global_load_dwordx4 v[108:111], v187, s[18:19] offset:0 nt
  s_waitcnt vmcnt(15)
  global_load_dwordx4 v[112:115], v187, s[18:19] offset:128 nt
  s_waitcnt vmcnt(15)
  global_load_dwordx4 v[116:119], v188, s[20:21] offset:0 nt
  s_waitcnt vmcnt(15)
  global_load_dwordx4 v[120:123], v188, s[20:21] offset:256 nt
  s_waitcnt vmcnt(15)
  global_load_dwordx4 v[124:127], v188, s[20:21] offset:512 nt
  s_waitcnt vmcnt(15)
  global_load_dwordx4 v[128:131], v188, s[20:21] offset:768 nt
  s_waitcnt vmcnt(15)
  global_load_dwordx4 v[132:135], v189, s[20:21] offset:0 nt
  s_waitcnt vmcnt(15)
  global_load_dwordx4 v[136:139], v189, s[20:21] offset:256 nt
  s_waitcnt vmcnt(15)
  global_load_dwordx4 v[140:143], v189, s[20:21] offset:512 nt
  s_waitcnt vmcnt(15)
  global_load_dwordx4 v[144:147], v189, s[20:21] offset:768 nt
  s_waitcnt vmcnt(15)
  global_load_dwordx4 v[148:151], v190, s[20:21] offset:0 nt
  s_waitcnt vmcnt(15)
  global_load_dwordx4 v[152:155], v190, s[20:21] offset:256 nt
  s_waitcnt vmcnt(15)
  global_load_dwordx4 v[156:159], v190, s[20:21] offset:512 nt
  s_waitcnt vmcnt(15)
  global_load_dwordx4 v[160:163], v190, s[20:21] offset:768 nt
  s_waitcnt vmcnt(15)
  global_load_dwordx4 v[164:167], v191, s[20:21] offset:0 nt
  s_waitcnt vmcnt(15)
  global_load_dwordx4 v[168:171], v191, s[20:21] offset:256 nt
  s_waitcnt vmcnt(15)
  global_load_dwordx4 v[172:175], v191, s[20:21] offset:512 nt
  s_waitcnt vmcnt(15)
  global_load_dwordx4 v[176:179], v191, s[20:21] offset:768 nt
  v_and_b32 v21, 1, v1
  v_lshlrev_b32 v21, 4, v21
  v_mov_b32 v20, 0xffff
  v_lshlrev_b32 v19, v21, v20
  v_bfe_u32 v20, v1, 1, 2
  v_cmp_eq_u32 vcc, 0, v20
  s_nop 1
  v_cndmask_b32 v2, 0, v19, vcc
  v_cmp_eq_u32 vcc, 1, v20
  s_nop 1
  v_cndmask_b32 v3, 0, v19, vcc
  v_cmp_eq_u32 vcc, 2, v20
  s_nop 1
  v_cndmask_b32 v4, 0, v19, vcc
  v_cmp_eq_u32 vcc, 3, v20
  s_nop 1
  v_cndmask_b32 v5, 0, v19, vcc
  v_bfe_u32 v9, v1, 2, 1
  v_lshlrev_b32 v9, 6, v9
  v_lshl_add_u32 v9, v25, 8, v9
  v_lshl_add_u32 v9, v24, 4, v9
  v_lshlrev_b32 v10, 6, v25
  s_lshl_b32 s53, s58, 4
  v_add_u32 v10, s53, v10
  s_lshl_b32 s53, s58, 10
  v_lshl_add_u32 v11, v1, 4, s53
  s_waitcnt lgkmcnt(0)
  s_add_u32 s48, s49, 0x10001
  v_mov_b32 v6, s48
  s_barrier
  ds_read_b128 v[36:39], v9 offset:1152
  ds_read_b128 v[40:43], v9 offset:1280
  s_mov_b32 vcc_lo, 0x0f0f0f0f
  s_mov_b32 vcc_hi, 0xf0f0f0f0
  s_waitcnt lgkmcnt(0)
  v_mfma_f32_16x16x32_bf16 v[180:183], v[52:55], v[36:39], 0
  v_mfma_f32_16x16x32_bf16 v[184:187], v[60:63], v[36:39], 0
  v_mfma_f32_16x16x32_bf16 v[188:191], v[68:71], v[36:39], 0
  v_mfma_f32_16x16x32_bf16 v[192:195], v[76:79], v[36:39], 0
  v_mfma_f32_16x16x32_bf16 v[196:199], v[84:87], v[36:39], 0
  v_mfma_f32_16x16x32_bf16 v[200:203], v[92:95], v[36:39], 0
  v_mfma_f32_16x16x32_bf16 v[204:207], v[100:103], v[36:39], 0
  v_mfma_f32_16x16x32_bf16 v[208:211], v[108:111], v[36:39], 0
  v_mfma_f32_16x16x32_bf16 v[180:183], v[56:59], v[40:43], v[180:183]
  v_mfma_f32_16x16x32_bf16 v[184:187], v[64:67], v[40:43], v[184:187]
  v_mfma_f32_16x16x32_bf16 v[188:191], v[72:75], v[40:43], v[188:191]
  v_mfma_f32_16x16x32_bf16 v[192:195], v[80:83], v[40:43], v[192:195]
  v_mfma_f32_16x16x32_bf16 v[196:199], v[88:91], v[40:43], v[196:199]
  v_mfma_f32_16x16x32_bf16 v[200:203], v[96:99], v[40:43], v[200:203]
  v_mfma_f32_16x16x32_bf16 v[204:207], v[104:107], v[40:43], v[204:207]
  v_mfma_f32_16x16x32_bf16 v[208:211], v[112:115], v[40:43], v[208:211]
  s_nop 0
  v_cndmask_b32_dpp v180, v180, v180, vcc row_half_mirror row_mask:0xf bank_mask:0xf
  v_cndmask_b32_dpp v181, v181, v181, vcc row_half_mirror row_mask:0xf bank_mask:0xf
  v_cndmask_b32_dpp v182, v182, v182, vcc row_half_mirror row_mask:0xf bank_mask:0xf
  v_cndmask_b32_dpp v183, v183, v183, vcc row_half_mirror row_mask:0xf bank_mask:0xf
  v_cndmask_b32_dpp v184, v184, v184, vcc row_half_mirror row_mask:0xf bank_mask:0xf
  v_cndmask_b32_dpp v185, v185, v185, vcc row_half_mirror row_mask:0xf bank_mask:0xf
  v_cndmask_b32_dpp v186, v186, v186, vcc row_half_mirror row_mask:0xf bank_mask:0xf
  v_cndmask_b32_dpp v187, v187, v187, vcc row_half_mirror row_mask:0xf bank_mask:0xf
  v_cndmask_b32_dpp v188, v188, v188, vcc row_half_mirror row_mask:0xf bank_mask:0xf
  v_cndmask_b32_dpp v189, v189, v189, vcc row_half_mirror row_mask:0xf bank_mask:0xf
  v_cndmask_b32_dpp v190, v190, v190, vcc row_half_mirror row_mask:0xf bank_mask:0xf
  v_cndmask_b32_dpp v191, v191, v191, vcc row_half_mirror row_mask:0xf bank_mask:0xf
  v_cndmask_b32_dpp v192, v192, v192, vcc row_half_mirror row_mask:0xf bank_mask:0xf
  v_cndmask_b32_dpp v193, v193, v193, vcc row_half_mirror row_mask:0xf bank_mask:0xf
  v_cndmask_b32_dpp v194, v194, v194, vcc row_half_mirror row_mask:0xf bank_mask:0xf
  v_cndmask_b32_dpp v195, v195, v195, vcc row_half_mirror row_mask:0xf bank_mask:0xf
  v_cndmask_b32_dpp v196, v196, v196, vcc row_half_mirror row_mask:0xf bank_mask:0xf
  v_cndmask_b32_dpp v197, v197, v197, vcc row_half_mirror row_mask:0xf bank_mask:0xf
  v_cndmask_b32_dpp v198, v198, v198, vcc row_half_mirror row_mask:0xf bank_mask:0xf
  v_cndmask_b32_dpp v199, v199, v199, vcc row_half_mirror row_mask:0xf bank_mask:0xf
  v_cndmask_b32_dpp v200, v200, v200, vcc row_half_mirror row_mask:0xf bank_mask:0xf
  v_cndmask_b32_dpp v201, v201, v201, vcc row_half_mirror row_mask:0xf bank_mask:0xf
  v_cndmask_b32_dpp v202, v202, v202, vcc row_half_mirror row_mask:0xf bank_mask:0xf
  v_cndmask_b32_dpp v203, v203, v203, vcc row_half_mirror row_mask:0xf bank_mask:0xf
  v_cndmask_b32_dpp v204, v204, v204, vcc row_half_mirror row_mask:0xf bank_mask:0xf
  v_cndmask_b32_dpp v205, v205, v205, vcc row_half_mirror row_mask:0xf bank_mask:0xf
  v_cndmask_b32_dpp v206, v206, v206, vcc row_half_mirror row_mask:0xf bank_mask:0xf
  v_cndmask_b32_dpp v207, v207, v207, vcc row_half_mirror row_mask:0xf bank_mask:0xf
  v_cndmask_b32_dpp v208, v208, v208, vcc row_half_mirror row_mask:0xf bank_mask:0xf
  v_cndmask_b32_dpp v209, v209, v209, vcc row_half_mirror row_mask:0xf bank_mask:0xf
  v_cndmask_b32_dpp v210, v210, v210, vcc row_half_mirror row_mask:0xf bank_mask:0xf
  v_cndmask_b32_dpp v211, v211, v211, vcc row_half_mirror row_mask:0xf bank_mask:0xf
  v_permlane32_swap_b32 v180, v184
  v_permlane32_swap_b32 v181, v185
  v_permlane32_swap_b32 v182, v186
  v_permlane32_swap_b32 v183, v187
  v_permlane32_swap_b32 v188, v192
  v_permlane32_swap_b32 v189, v193
  v_permlane32_swap_b32 v190, v194
  v_permlane32_swap_b32 v191, v195
  v_permlane32_swap_b32 v196, v200
  v_permlane32_swap_b32 v197, v201
  v_permlane32_swap_b32 v198, v202
  v_permlane32_swap_b32 v199, v203
  v_permlane32_swap_b32 v204, v208
  v_permlane32_swap_b32 v205, v209
  v_permlane32_swap_b32 v206, v210
  v_permlane32_swap_b32 v207, v211
  v_add_f32 v212, v180, v184
  v_add_f32 v213, v181, v185
  v_add_f32 v214, v182, v186
  v_add_f32 v215, v183, v187
  v_add_f32 v216, v188, v192
  v_add_f32 v217, v189, v193
  v_add_f32 v218, v190, v194
  v_add_f32 v219, v191, v195
  v_add_f32 v220, v196, v200
  v_add_f32 v221, v197, v201
  v_add_f32 v222, v198, v202
  v_add_f32 v223, v199, v203
  v_add_f32 v224, v204, v208
  v_add_f32 v225, v205, v209
  v_add_f32 v226, v206, v210
  v_add_f32 v227, v207, v211
  v_cvt_pk_bf16_f32 v212, 0, v212
  v_cvt_pk_bf16_f32 v213, 0, v213
  v_cvt_pk_bf16_f32 v214, 0, v214
  v_cvt_pk_bf16_f32 v215, 0, v215
  v_cvt_pk_bf16_f32 v216, 0, v216
  v_cvt_pk_bf16_f32 v217, 0, v217
  v_cvt_pk_bf16_f32 v218, 0, v218
  v_cvt_pk_bf16_f32 v219, 0, v219
  v_cvt_pk_bf16_f32 v220, 0, v220
  v_cvt_pk_bf16_f32 v221, 0, v221
  v_cvt_pk_bf16_f32 v222, 0, v222
  v_cvt_pk_bf16_f32 v223, 0, v223
  v_cvt_pk_bf16_f32 v224, 0, v224
  v_cvt_pk_bf16_f32 v225, 0, v225
  v_cvt_pk_bf16_f32 v226, 0, v226
  v_cvt_pk_bf16_f32 v227, 0, v227
  v_mul_f32 v212, 0x3db504f3, v212
  v_mul_f32 v213, 0x3db504f3, v213
  v_mul_f32 v214, 0x3db504f3, v214
  v_mul_f32 v215, 0x3db504f3, v215
  v_mul_f32 v216, 0x3db504f3, v216
  v_mul_f32 v217, 0x3db504f3, v217
  v_mul_f32 v218, 0x3db504f3, v218
  v_mul_f32 v219, 0x3db504f3, v219
  v_mul_f32 v220, 0x3db504f3, v220
  v_mul_f32 v221, 0x3db504f3, v221
  v_mul_f32 v222, 0x3db504f3, v222
  v_mul_f32 v223, 0x3db504f3, v223
  v_mul_f32 v224, 0x3db504f3, v224
  v_mul_f32 v225, 0x3db504f3, v225
  v_mul_f32 v226, 0x3db504f3, v226
  v_mul_f32 v227, 0x3db504f3, v227
  v_cvt_pk_bf16_f32 v212, 0, v212
  v_cvt_pk_bf16_f32 v213, 0, v213
  v_cvt_pk_bf16_f32 v214, 0, v214
  v_cvt_pk_bf16_f32 v215, 0, v215
  v_cvt_pk_bf16_f32 v216, 0, v216
  v_cvt_pk_bf16_f32 v217, 0, v217
  v_cvt_pk_bf16_f32 v218, 0, v218
  v_cvt_pk_bf16_f32 v219, 0, v219
  v_cvt_pk_bf16_f32 v220, 0, v220
  v_cvt_pk_bf16_f32 v221, 0, v221
  v_cvt_pk_bf16_f32 v222, 0, v222
  v_cvt_pk_bf16_f32 v223, 0, v223
  v_cvt_pk_bf16_f32 v224, 0, v224
  v_cvt_pk_bf16_f32 v225, 0, v225
  v_cvt_pk_bf16_f32 v226, 0, v226
  v_cvt_pk_bf16_f32 v227, 0, v227
  v_max3_f32 v12, v212, v213, v214
  v_max3_f32 v13, v215, v216, v217
  v_max3_f32 v12, v12, v218, v219
  v_max3_f32 v13, v13, v220, v221
  v_max3_f32 v12, v12, v222, v223
  v_max3_f32 v13, v13, v224, v225
  v_max3_f32 v12, v12, v226, v227
  v_max_f32 v12, v12, v13
  v_mov_b32 v13, v12
  s_nop 1
  v_permlane16_swap_b32 v12, v13
  v_max_f32 v12, v12, v13
  v_mov_b32 v13, v12
  s_nop 1
  v_permlane32_swap_b32 v12, v13
  v_max_f32 v12, v12, v13
  v_sub_f32 v212, v212, v12
  v_sub_f32 v213, v213, v12
  v_sub_f32 v214, v214, v12
  v_sub_f32 v215, v215, v12
  v_sub_f32 v216, v216, v12
  v_sub_f32 v217, v217, v12
  v_sub_f32 v218, v218, v12
  v_sub_f32 v219, v219, v12
  v_sub_f32 v220, v220, v12
  v_sub_f32 v221, v221, v12
  v_sub_f32 v222, v222, v12
  v_sub_f32 v223, v223, v12
  v_sub_f32 v224, v224, v12
  v_sub_f32 v225, v225, v12
  v_sub_f32 v226, v226, v12
  v_sub_f32 v227, v227, v12
  v_mul_f32 v212, 0x3fb8aa3b, v212
  v_mul_f32 v213, 0x3fb8aa3b, v213
  v_mul_f32 v214, 0x3fb8aa3b, v214
  v_mul_f32 v215, 0x3fb8aa3b, v215
  v_mul_f32 v216, 0x3fb8aa3b, v216
  v_mul_f32 v217, 0x3fb8aa3b, v217
  v_mul_f32 v218, 0x3fb8aa3b, v218
  v_mul_f32 v219, 0x3fb8aa3b, v219
  v_mul_f32 v220, 0x3fb8aa3b, v220
  v_mul_f32 v221, 0x3fb8aa3b, v221
  v_mul_f32 v222, 0x3fb8aa3b, v222
  v_mul_f32 v223, 0x3fb8aa3b, v223
  v_mul_f32 v224, 0x3fb8aa3b, v224
  v_mul_f32 v225, 0x3fb8aa3b, v225
  v_mul_f32 v226, 0x3fb8aa3b, v226
  v_mul_f32 v227, 0x3fb8aa3b, v227
  v_exp_f32 v212, v212
  v_exp_f32 v213, v213
  v_exp_f32 v214, v214
  v_exp_f32 v215, v215
  v_exp_f32 v216, v216
  v_exp_f32 v217, v217
  v_exp_f32 v218, v218
  v_exp_f32 v219, v219
  v_exp_f32 v220, v220
  v_exp_f32 v221, v221
  v_exp_f32 v222, v222
  v_exp_f32 v223, v223
  v_exp_f32 v224, v224
  v_exp_f32 v225, v225
  v_exp_f32 v226, v226
  v_exp_f32 v227, v227
  v_add_f32 v14, v212, v213
  v_add_f32 v15, v214, v215
  v_add_f32 v14, v14, v216
  v_add_f32 v15, v15, v217
  v_add_f32 v14, v14, v218
  v_add_f32 v15, v15, v219
  v_add_f32 v14, v14, v220
  v_add_f32 v15, v15, v221
  v_add_f32 v14, v14, v222
  v_add_f32 v15, v15, v223
  v_add_f32 v14, v14, v224
  v_add_f32 v15, v15, v225
  v_add_f32 v14, v14, v226
  v_add_f32 v15, v15, v227
  v_add_f32 v14, v14, v15
  v_mov_b32 v13, v14
  s_nop 1
  v_permlane16_swap_b32 v14, v13
  v_add_f32 v14, v14, v13
  v_mov_b32 v13, v14
  s_nop 1
  v_permlane32_swap_b32 v14, v13
  v_add_f32 v14, v14, v13
  v_mov_b32 v44, v12
  v_mov_b32 v45, v14
  v_mov_b32 v46, 1
  s_mov_b64 exec, 0x101
  ds_write_b64 v10, v[44:45] offset:1664
  ds_write_b32 v10, v46 offset:1672
  s_mov_b64 exec, -1
  v_cvt_pk_bf16_f32 v212, v212, v212
  v_cvt_pk_bf16_f32 v213, v213, v213
  v_cvt_pk_bf16_f32 v214, v214, v214
  v_cvt_pk_bf16_f32 v215, v215, v215
  v_cvt_pk_bf16_f32 v216, v216, v216
  v_cvt_pk_bf16_f32 v217, v217, v217
  v_cvt_pk_bf16_f32 v218, v218, v218
  v_cvt_pk_bf16_f32 v219, v219, v219
  v_cvt_pk_bf16_f32 v220, v220, v220
  v_cvt_pk_bf16_f32 v221, v221, v221
  v_cvt_pk_bf16_f32 v222, v222, v222
  v_cvt_pk_bf16_f32 v223, v223, v223
  v_cvt_pk_bf16_f32 v224, v224, v224
  v_cvt_pk_bf16_f32 v225, v225, v225
  v_cvt_pk_bf16_f32 v226, v226, v226
  v_cvt_pk_bf16_f32 v227, v227, v227
  v_and_b32 v52, v212, v2
  v_and_b32 v53, v212, v3
  v_and_b32 v54, v212, v4
  v_and_b32 v55, v212, v5
  v_and_b32 v56, v213, v2
  v_and_b32 v57, v213, v3
  v_and_b32 v58, v213, v4
  v_and_b32 v59, v213, v5
  s_waitcnt vmcnt(15)
  v_mfma_f32_16x16x32_bf16 v[228:231], v[116:119], v[52:55], 0
  v_and_b32 v60, v214, v2
  v_and_b32 v61, v214, v3
  v_and_b32 v62, v214, v4
  v_and_b32 v63, v214, v5
  s_waitcnt vmcnt(14)
  v_mfma_f32_16x16x32_bf16 v[228:231], v[120:123], v[56:59], v[228:231]
  v_and_b32 v64, v215, v2
  v_and_b32 v65, v215, v3
  v_and_b32 v66, v215, v4
  v_and_b32 v67, v215, v5
  s_waitcnt vmcnt(13)
  v_mfma_f32_16x16x32_bf16 v[228:231], v[124:127], v[60:63], v[228:231]
  v_and_b32 v68, v216, v2
  v_and_b32 v69, v216, v3
  v_and_b32 v70, v216, v4
  v_and_b32 v71, v216, v5
  s_waitcnt vmcnt(12)
  v_mfma_f32_16x16x32_bf16 v[228:231], v[128:131], v[64:67], v[228:231]
  v_and_b32 v72, v217, v2
  v_and_b32 v73, v217, v3
  v_and_b32 v74, v217, v4
  v_and_b32 v75, v217, v5
  s_waitcnt vmcnt(11)
  v_mfma_f32_16x16x32_bf16 v[228:231], v[132:135], v[68:71], v[228:231]
  v_and_b32 v76, v218, v2
  v_and_b32 v77, v218, v3
  v_and_b32 v78, v218, v4
  v_and_b32 v79, v218, v5
  s_waitcnt vmcnt(10)
  v_mfma_f32_16x16x32_bf16 v[228:231], v[136:139], v[72:75], v[228:231]
  v_and_b32 v80, v219, v2
  v_and_b32 v81, v219, v3
  v_and_b32 v82, v219, v4
  v_and_b32 v83, v219, v5
  s_waitcnt vmcnt(9)
  v_mfma_f32_16x16x32_bf16 v[228:231], v[140:143], v[76:79], v[228:231]
  v_and_b32 v84, v220, v2
  v_and_b32 v85, v220, v3
  v_and_b32 v86, v220, v4
  v_and_b32 v87, v220, v5
  s_waitcnt vmcnt(8)
  v_mfma_f32_16x16x32_bf16 v[228:231], v[144:147], v[80:83], v[228:231]
  v_and_b32 v88, v221, v2
  v_and_b32 v89, v221, v3
  v_and_b32 v90, v221, v4
  v_and_b32 v91, v221, v5
  s_waitcnt vmcnt(7)
  v_mfma_f32_16x16x32_bf16 v[228:231], v[148:151], v[84:87], v[228:231]
  v_and_b32 v92, v222, v2
  v_and_b32 v93, v222, v3
  v_and_b32 v94, v222, v4
  v_and_b32 v95, v222, v5
  s_waitcnt vmcnt(6)
  v_mfma_f32_16x16x32_bf16 v[228:231], v[152:155], v[88:91], v[228:231]
  v_and_b32 v96, v223, v2
  v_and_b32 v97, v223, v3
  v_and_b32 v98, v223, v4
  v_and_b32 v99, v223, v5
  s_waitcnt vmcnt(5)
  v_mfma_f32_16x16x32_bf16 v[228:231], v[156:159], v[92:95], v[228:231]
  v_and_b32 v100, v224, v2
  v_and_b32 v101, v224, v3
  v_and_b32 v102, v224, v4
  v_and_b32 v103, v224, v5
  s_waitcnt vmcnt(4)
  v_mfma_f32_16x16x32_bf16 v[228:231], v[160:163], v[96:99], v[228:231]
  v_and_b32 v104, v225, v2
  v_and_b32 v105, v225, v3
  v_and_b32 v106, v225, v4
  v_and_b32 v107, v225, v5
  s_waitcnt vmcnt(3)
  v_mfma_f32_16x16x32_bf16 v[228:231], v[164:167], v[100:103], v[228:231]
  v_and_b32 v108, v226, v2
  v_and_b32 v109, v226, v3
  v_and_b32 v110, v226, v4
  v_and_b32 v111, v226, v5
  s_waitcnt vmcnt(2)
  v_mfma_f32_16x16x32_bf16 v[228:231], v[168:171], v[104:107], v[228:231]
  v_and_b32 v112, v227, v2
  v_and_b32 v113, v227, v3
  v_and_b32 v114, v227, v4
  v_and_b32 v115, v227, v5
  s_waitcnt vmcnt(1)
  v_mfma_f32_16x16x32_bf16 v[228:231], v[172:175], v[108:111], v[228:231]
  s_waitcnt vmcnt(0)
  v_mfma_f32_16x16x32_bf16 v[228:231], v[176:179], v[112:115], v[228:231]
  s_nop 7
  ds_write_b128 v11, v[228:231] offset:1792
  s_waitcnt lgkmcnt(0)
  s_barrier
  s_cmp_ge_u32 s43, 12
  s_cbranch_scc1 L_RED
L_fin:
L_end:
  s_endpgm
L_codeend:
  s_endpgm
.section .rodata,"a"
.p2align 6
.amdhsa_kernel recurrent_scan__sliding_block_cached__mixer_token_mlp__decode_kernel
  .amdhsa_next_free_vgpr 236
  .amdhsa_next_free_sgpr 100
  .amdhsa_accum_offset 236
  .amdhsa_group_segment_fixed_size 0
  .amdhsa_kernarg_size 104
  .amdhsa_user_sgpr_count 2
  .amdhsa_user_sgpr_kernarg_segment_ptr 1
  .amdhsa_system_sgpr_workgroup_id_x 1
  .amdhsa_float_denorm_mode_32 3
  .amdhsa_float_denorm_mode_16_64 3
.end_amdhsa_kernel
```
